```python
import torch

def _softmax(x, axis=-1):
    return torch.softmax(x, dim=axis)

def _gelu(x):
    return torch.nn.functional.gelu(x, approximate='tanh')

def _silu(x):
    return torch.nn.functional.silu(x)

def _sigmoid(x):
    return torch.sigmoid(x)

def _layernorm(x, axis=-1, eps=1e-05):
    m = x.mean(dim=axis, keepdim=True)
    v = x.var(dim=axis, keepdim=True, unbiased=False)
    return (x - m) / torch.sqrt(v + eps)

def _scatter_add(tgt, idx, src, axis=0):
    return tgt.clone().index_add_(axis, idx, src)

def _segment_sum(src, seg, n):
    out = torch.zeros((n,) + src.shape[1:], dtype=src.dtype)
    return out.index_add_(0, seg, src)

def _pad(x, pw):
    flat = tuple((v for pair in reversed(pw) for v in pair))
    return torch.nn.functional.pad(x, flat)
kernel_name = 'parallel_sum__memory_aug_recurrent_mem_tr__mixer_channel_mlp__prompt'

def setup_inputs():

    _w = lambda a: (lambda t: t.to(torch.bfloat16) if t.is_floating_point() else t)(torch.as_tensor(a))

    def _A_setup():
        B, S, Dm = (1, 2048, 1024)
        H, Dh = (32, 128)
        M, seg = (8, 32)
        seg = min(seg, S)
        S = S // seg * seg
        return {'x': _w((lambda *s: torch.randn(*s, dtype=torch.bfloat16) * 0.05)(B, S, Dm)), 'mem0': _w((lambda *s: torch.randn(*s, dtype=torch.bfloat16) * 0.2)(B, M, Dm)), 'Wq': _w((lambda *s: torch.randn(*s, dtype=torch.bfloat16) * 1.6)(Dm, H, Dh) * Dm ** (-0.5)), 'Wk': _w((lambda *s: torch.randn(*s, dtype=torch.bfloat16) * 1.6)(Dm, H, Dh) * Dm ** (-0.5)), 'Wv': _w((lambda *s: torch.randn(*s, dtype=torch.bfloat16) * 0.2)(Dm, H, Dh) * Dm ** (-0.5)), 'Wo': _w((lambda *s: torch.randn(*s, dtype=torch.bfloat16) * 0.2)(H, Dh, Dm) * (H * Dh) ** (-0.5)), 'seg_len': seg}
    _A_in = _A_setup()

    def _B_setup():
        B, S, D, F = (1, 2048, 1024, 3584)
        return {'x': _w((lambda *s: torch.randn(*s, dtype=torch.bfloat16) * 0.05)(B, S, D)), 'w1': _w((lambda *s: torch.randn(*s, dtype=torch.bfloat16) * 1.6)(D, F) * D ** (-0.5)), 'b1': _w((lambda *s: torch.randn(*s, dtype=torch.bfloat16) * 0.4)(F)), 'w2': _w((lambda *s: torch.randn(*s, dtype=torch.bfloat16) * 0.05)(F, D) * F ** (-0.5)), 'b2': _w((lambda *s: torch.randn(*s, dtype=torch.bfloat16) * 0.05)(D))}
    _B_in = _B_setup()
    return {'A_x': _A_in['x'], 'A_mem0': _A_in['mem0'], 'A_Wq': _A_in['Wq'], 'A_Wk': _A_in['Wk'], 'A_Wv': _A_in['Wv'], 'A_Wo': _A_in['Wo'], 'A_seg_len': _A_in['seg_len'], 'B_x': _B_in['x'], 'B_w1': _B_in['w1'], 'B_b1': _B_in['b1'], 'B_w2': _B_in['w2'], 'B_b2': _B_in['b2']}

def reference(A_x, A_mem0, A_Wq, A_Wk, A_Wv, A_Wo, A_seg_len, B_x, B_w1, B_b1, B_w2, B_b2):

    def _A_ref(x, mem0, Wq, Wk, Wv, Wo, seg_len):
        B, S, Dm = x.shape
        H, Dh = (Wq.shape[1], Wq.shape[2])
        M = mem0.shape[1]
        scale = Dh ** (-0.5)
        n_seg = S // seg_len
        L = M + seg_len
        idx = torch.arange(L)
        mask = (idx[:, None] < M) | (idx[:, None] >= idx[None, :])
        mem = mem0
        outs = []
        for s in range(n_seg):
            xs = x[:, s * seg_len:(s + 1) * seg_len, :].clone()
            h = torch.concatenate([mem, xs], axis=1)
            q = torch.einsum('btd,dhe->bhte', h, Wq)
            k = torch.einsum('btd,dhe->bhte', h, Wk)
            v = torch.einsum('btd,dhe->bhte', h, Wv)
            scores = torch.einsum('bhqe,bhke->bhqk', q, k) * scale
            scores = torch.where(mask[None, None], scores, -1000000000.0)
            p = _softmax(scores, axis=-1)
            o = torch.einsum('bhqk,bhke->bhqe', p, v)
            o = torch.einsum('bhte,hed->btd', o, Wo)
            mem = o[:, :M, :].clone()
            outs.append(o[:, M:, :])
        return torch.concatenate(outs, axis=1)

    def _B_ref(x, w1, b1, w2, b2):
        y = _layernorm(x, axis=-1)
        h = _gelu(torch.einsum('bsd,df->bsf', y, w1) + b1)
        return torch.einsum('bsf,fd->bsd', h, w2) + b2
    x = A_x
    xn = _layernorm(x, axis=-1)
    return x + _A_ref(xn, A_mem0, A_Wq, A_Wk, A_Wv, A_Wo, A_seg_len) + _B_ref(xn, B_w1, B_b1, B_w2, B_b2)
```

```asm
; @launch kernel=ln_kernel grid=(512,1,1) block=(256,1,1) lds=0
; @launch kernel=rec_kernel grid=(256,1,1) block=(512,1,1) lds=155648
.amdgcn_target "amdgcn-amd-amdhsa--gfx950"
.text
.globl ln_kernel
.p2align 8
.type ln_kernel,@function
ln_kernel:
    s_cmp_ge_u32 s2, 512
    s_cbranch_scc1 ln_done
    s_load_dwordx2 s[4:5], s[0:1], 0
    s_load_dwordx2 s[6:7], s[0:1], 112
    s_waitcnt lgkmcnt(0)
    s_mov_b32 s8, s4
    s_mov_b32 s9, s5
    s_mov_b32 s10, 4194304
    s_mov_b32 s11, 0x00020000
    s_mov_b32 s12, s6
    s_mov_b32 s13, s7
    s_mov_b32 s14, 268435456
    s_mov_b32 s15, 0x00020000
    v_lshrrev_b32 v1, 6, v0
    v_and_b32 v2, 63, v0
    s_lshl_b32 s3, s2, 2
    v_add_u32 v1, s3, v1
    v_lshlrev_b32 v1, 11, v1
    v_lshlrev_b32 v3, 4, v2
    v_add_u32 v1, v1, v3
    buffer_load_dwordx4 v[4:7], v1, s[8:11], 0 offen
    buffer_load_dwordx4 v[8:11], v1, s[8:11], 0 offen offset:1024
    v_mov_b32 v40, -1
    v_mov_b32 v41, -1
    v_mov_b32 v42, -1
    v_mov_b32 v43, -1
    s_lshl_b32 s3, s2, 15
    s_add_u32 s3, s3, 100663296
    v_lshlrev_b32 v44, 4, v0
    buffer_store_dwordx4 v[40:43], v44, s[12:15], s3 offen
    s_add_u32 s3, s3, 4096
    buffer_store_dwordx4 v[40:43], v44, s[12:15], s3 offen
    s_add_u32 s3, s3, 4096
    buffer_store_dwordx4 v[40:43], v44, s[12:15], s3 offen
    s_add_u32 s3, s3, 4096
    buffer_store_dwordx4 v[40:43], v44, s[12:15], s3 offen
    s_add_u32 s3, s3, 4096
    buffer_store_dwordx4 v[40:43], v44, s[12:15], s3 offen
    s_add_u32 s3, s3, 4096
    buffer_store_dwordx4 v[40:43], v44, s[12:15], s3 offen
    s_add_u32 s3, s3, 4096
    buffer_store_dwordx4 v[40:43], v44, s[12:15], s3 offen
    s_add_u32 s3, s3, 4096
    buffer_store_dwordx4 v[40:43], v44, s[12:15], s3 offen
    s_add_u32 s3, s3, 4096
    s_lshl_b32 s3, s2, 15
    s_add_u32 s3, s3, 184549376
    buffer_store_dwordx4 v[40:43], v44, s[12:15], s3 offen
    s_add_u32 s3, s3, 4096
    buffer_store_dwordx4 v[40:43], v44, s[12:15], s3 offen
    s_add_u32 s3, s3, 4096
    buffer_store_dwordx4 v[40:43], v44, s[12:15], s3 offen
    s_add_u32 s3, s3, 4096
    buffer_store_dwordx4 v[40:43], v44, s[12:15], s3 offen
    s_add_u32 s3, s3, 4096
    buffer_store_dwordx4 v[40:43], v44, s[12:15], s3 offen
    s_add_u32 s3, s3, 4096
    buffer_store_dwordx4 v[40:43], v44, s[12:15], s3 offen
    s_add_u32 s3, s3, 4096
    buffer_store_dwordx4 v[40:43], v44, s[12:15], s3 offen
    s_add_u32 s3, s3, 4096
    buffer_store_dwordx4 v[40:43], v44, s[12:15], s3 offen
    s_add_u32 s3, s3, 4096
    s_cmp_lg_u32 s2, 0
    s_cbranch_scc1 ln_nocnt
    v_mov_b32 v45, 0
    v_lshlrev_b32 v46, 2, v0
    s_mov_b32 s3, 117440512
    buffer_store_dword v45, v46, s[12:15], s3 offen
ln_nocnt:
    s_waitcnt vmcnt(16)
    v_lshlrev_b32 v12, 16, v4
    v_and_b32 v13, 0xffff0000, v4
    v_lshlrev_b32 v14, 16, v5
    v_and_b32 v15, 0xffff0000, v5
    v_lshlrev_b32 v16, 16, v6
    v_and_b32 v17, 0xffff0000, v6
    v_lshlrev_b32 v18, 16, v7
    v_and_b32 v19, 0xffff0000, v7
    v_lshlrev_b32 v20, 16, v8
    v_and_b32 v21, 0xffff0000, v8
    v_lshlrev_b32 v22, 16, v9
    v_and_b32 v23, 0xffff0000, v9
    v_lshlrev_b32 v24, 16, v10
    v_and_b32 v25, 0xffff0000, v10
    v_lshlrev_b32 v26, 16, v11
    v_and_b32 v27, 0xffff0000, v11
    v_add_f32 v28, v12, v13
    v_add_f32 v28, v28, v14
    v_add_f32 v28, v28, v15
    v_add_f32 v28, v28, v16
    v_add_f32 v28, v28, v17
    v_add_f32 v28, v28, v18
    v_add_f32 v28, v28, v19
    v_add_f32 v28, v28, v20
    v_add_f32 v28, v28, v21
    v_add_f32 v28, v28, v22
    v_add_f32 v28, v28, v23
    v_add_f32 v28, v28, v24
    v_add_f32 v28, v28, v25
    v_add_f32 v28, v28, v26
    v_add_f32 v28, v28, v27
    ds_swizzle_b32 v29, v28 offset:0x41f
    s_waitcnt lgkmcnt(0)
    v_add_f32 v28, v28, v29
    ds_swizzle_b32 v29, v28 offset:0x81f
    s_waitcnt lgkmcnt(0)
    v_add_f32 v28, v28, v29
    ds_swizzle_b32 v29, v28 offset:0x101f
    s_waitcnt lgkmcnt(0)
    v_add_f32 v28, v28, v29
    ds_swizzle_b32 v29, v28 offset:0x201f
    s_waitcnt lgkmcnt(0)
    v_add_f32 v28, v28, v29
    ds_swizzle_b32 v29, v28 offset:0x401f
    s_waitcnt lgkmcnt(0)
    v_add_f32 v28, v28, v29
    s_nop 1
    v_readlane_b32 s16, v28, 32
    s_nop 3
    v_add_f32 v28, s16, v28
    s_nop 1
    v_readlane_b32 s16, v28, 0
    s_nop 3
    v_mov_b32 v28, 0x3a800000
    v_mul_f32 v30, s16, v28
    v_sub_f32 v29, v12, v30
    v_mul_f32 v28, v29, v29
    v_sub_f32 v29, v13, v30
    v_fmac_f32 v28, v29, v29
    v_sub_f32 v29, v14, v30
    v_fmac_f32 v28, v29, v29
    v_sub_f32 v29, v15, v30
    v_fmac_f32 v28, v29, v29
    v_sub_f32 v29, v16, v30
    v_fmac_f32 v28, v29, v29
    v_sub_f32 v29, v17, v30
    v_fmac_f32 v28, v29, v29
    v_sub_f32 v29, v18, v30
    v_fmac_f32 v28, v29, v29
    v_sub_f32 v29, v19, v30
    v_fmac_f32 v28, v29, v29
    v_sub_f32 v29, v20, v30
    v_fmac_f32 v28, v29, v29
    v_sub_f32 v29, v21, v30
    v_fmac_f32 v28, v29, v29
    v_sub_f32 v29, v22, v30
    v_fmac_f32 v28, v29, v29
    v_sub_f32 v29, v23, v30
    v_fmac_f32 v28, v29, v29
    v_sub_f32 v29, v24, v30
    v_fmac_f32 v28, v29, v29
    v_sub_f32 v29, v25, v30
    v_fmac_f32 v28, v29, v29
    v_sub_f32 v29, v26, v30
    v_fmac_f32 v28, v29, v29
    v_sub_f32 v29, v27, v30
    v_fmac_f32 v28, v29, v29
    ds_swizzle_b32 v29, v28 offset:0x41f
    s_waitcnt lgkmcnt(0)
    v_add_f32 v28, v28, v29
    ds_swizzle_b32 v29, v28 offset:0x81f
    s_waitcnt lgkmcnt(0)
    v_add_f32 v28, v28, v29
    ds_swizzle_b32 v29, v28 offset:0x101f
    s_waitcnt lgkmcnt(0)
    v_add_f32 v28, v28, v29
    ds_swizzle_b32 v29, v28 offset:0x201f
    s_waitcnt lgkmcnt(0)
    v_add_f32 v28, v28, v29
    ds_swizzle_b32 v29, v28 offset:0x401f
    s_waitcnt lgkmcnt(0)
    v_add_f32 v28, v28, v29
    s_nop 1
    v_readlane_b32 s17, v28, 32
    s_nop 3
    v_add_f32 v28, s17, v28
    s_nop 1
    v_readlane_b32 s17, v28, 0
    s_nop 3
    v_mov_b32 v28, 0x3a800000
    v_mul_f32 v31, s17, v28
    v_cvt_pk_bf16_f32 v30, v30, v30
    v_lshlrev_b32 v30, 16, v30
    v_cvt_pk_bf16_f32 v31, v31, v31
    v_lshlrev_b32 v31, 16, v31
    v_add_f32 v31, 0x3727c5ac, v31
    v_cvt_pk_bf16_f32 v31, v31, v31
    v_lshlrev_b32 v31, 16, v31
    v_sqrt_f32 v31, v31
    s_nop 0
    v_cvt_pk_bf16_f32 v31, v31, v31
    v_lshlrev_b32 v31, 16, v31
    v_rcp_f32 v31, v31
    s_nop 0
    v_sub_f32 v29, v12, v30
    v_cvt_pk_bf16_f32 v29, v29, v29
    v_lshlrev_b32 v29, 16, v29
    v_mul_f32 v12, v29, v31
    v_sub_f32 v29, v13, v30
    v_cvt_pk_bf16_f32 v29, v29, v29
    v_lshlrev_b32 v29, 16, v29
    v_mul_f32 v13, v29, v31
    v_sub_f32 v29, v14, v30
    v_cvt_pk_bf16_f32 v29, v29, v29
    v_lshlrev_b32 v29, 16, v29
    v_mul_f32 v14, v29, v31
    v_sub_f32 v29, v15, v30
    v_cvt_pk_bf16_f32 v29, v29, v29
    v_lshlrev_b32 v29, 16, v29
    v_mul_f32 v15, v29, v31
    v_sub_f32 v29, v16, v30
    v_cvt_pk_bf16_f32 v29, v29, v29
    v_lshlrev_b32 v29, 16, v29
    v_mul_f32 v16, v29, v31
    v_sub_f32 v29, v17, v30
    v_cvt_pk_bf16_f32 v29, v29, v29
    v_lshlrev_b32 v29, 16, v29
    v_mul_f32 v17, v29, v31
    v_sub_f32 v29, v18, v30
    v_cvt_pk_bf16_f32 v29, v29, v29
    v_lshlrev_b32 v29, 16, v29
    v_mul_f32 v18, v29, v31
    v_sub_f32 v29, v19, v30
    v_cvt_pk_bf16_f32 v29, v29, v29
    v_lshlrev_b32 v29, 16, v29
    v_mul_f32 v19, v29, v31
    v_sub_f32 v29, v20, v30
    v_cvt_pk_bf16_f32 v29, v29, v29
    v_lshlrev_b32 v29, 16, v29
    v_mul_f32 v20, v29, v31
    v_sub_f32 v29, v21, v30
    v_cvt_pk_bf16_f32 v29, v29, v29
    v_lshlrev_b32 v29, 16, v29
    v_mul_f32 v21, v29, v31
    v_sub_f32 v29, v22, v30
    v_cvt_pk_bf16_f32 v29, v29, v29
    v_lshlrev_b32 v29, 16, v29
    v_mul_f32 v22, v29, v31
    v_sub_f32 v29, v23, v30
    v_cvt_pk_bf16_f32 v29, v29, v29
    v_lshlrev_b32 v29, 16, v29
    v_mul_f32 v23, v29, v31
    v_sub_f32 v29, v24, v30
    v_cvt_pk_bf16_f32 v29, v29, v29
    v_lshlrev_b32 v29, 16, v29
    v_mul_f32 v24, v29, v31
    v_sub_f32 v29, v25, v30
    v_cvt_pk_bf16_f32 v29, v29, v29
    v_lshlrev_b32 v29, 16, v29
    v_mul_f32 v25, v29, v31
    v_sub_f32 v29, v26, v30
    v_cvt_pk_bf16_f32 v29, v29, v29
    v_lshlrev_b32 v29, 16, v29
    v_mul_f32 v26, v29, v31
    v_sub_f32 v29, v27, v30
    v_cvt_pk_bf16_f32 v29, v29, v29
    v_lshlrev_b32 v29, 16, v29
    v_mul_f32 v27, v29, v31
    v_cvt_pk_bf16_f32 v4, v12, v13
    v_cvt_pk_bf16_f32 v5, v14, v15
    v_cvt_pk_bf16_f32 v6, v16, v17
    v_cvt_pk_bf16_f32 v7, v18, v19
    v_cvt_pk_bf16_f32 v8, v20, v21
    v_cvt_pk_bf16_f32 v9, v22, v23
    v_cvt_pk_bf16_f32 v10, v24, v25
    v_cvt_pk_bf16_f32 v11, v26, v27
    s_mov_b32 s3, 0
    buffer_store_dwordx4 v[4:7], v1, s[12:15], s3 offen
    buffer_store_dwordx4 v[8:11], v1, s[12:15], s3 offen offset:1024
    v_lshlrev_b32 v12, 16, v4
    v_and_b32 v13, 0xffff0000, v4
    v_lshlrev_b32 v14, 16, v5
    v_and_b32 v15, 0xffff0000, v5
    v_lshlrev_b32 v16, 16, v6
    v_and_b32 v17, 0xffff0000, v6
    v_lshlrev_b32 v18, 16, v7
    v_and_b32 v19, 0xffff0000, v7
    v_lshlrev_b32 v20, 16, v8
    v_and_b32 v21, 0xffff0000, v8
    v_lshlrev_b32 v22, 16, v9
    v_and_b32 v23, 0xffff0000, v9
    v_lshlrev_b32 v24, 16, v10
    v_and_b32 v25, 0xffff0000, v10
    v_lshlrev_b32 v26, 16, v11
    v_and_b32 v27, 0xffff0000, v11
    v_add_f32 v28, v12, v13
    v_add_f32 v28, v28, v14
    v_add_f32 v28, v28, v15
    v_add_f32 v28, v28, v16
    v_add_f32 v28, v28, v17
    v_add_f32 v28, v28, v18
    v_add_f32 v28, v28, v19
    v_add_f32 v28, v28, v20
    v_add_f32 v28, v28, v21
    v_add_f32 v28, v28, v22
    v_add_f32 v28, v28, v23
    v_add_f32 v28, v28, v24
    v_add_f32 v28, v28, v25
    v_add_f32 v28, v28, v26
    v_add_f32 v28, v28, v27
    ds_swizzle_b32 v29, v28 offset:0x41f
    s_waitcnt lgkmcnt(0)
    v_add_f32 v28, v28, v29
    ds_swizzle_b32 v29, v28 offset:0x81f
    s_waitcnt lgkmcnt(0)
    v_add_f32 v28, v28, v29
    ds_swizzle_b32 v29, v28 offset:0x101f
    s_waitcnt lgkmcnt(0)
    v_add_f32 v28, v28, v29
    ds_swizzle_b32 v29, v28 offset:0x201f
    s_waitcnt lgkmcnt(0)
    v_add_f32 v28, v28, v29
    ds_swizzle_b32 v29, v28 offset:0x401f
    s_waitcnt lgkmcnt(0)
    v_add_f32 v28, v28, v29
    s_nop 1
    v_readlane_b32 s16, v28, 32
    s_nop 3
    v_add_f32 v28, s16, v28
    s_nop 1
    v_readlane_b32 s16, v28, 0
    s_nop 3
    v_mov_b32 v28, 0x3a800000
    v_mul_f32 v30, s16, v28
    v_sub_f32 v29, v12, v30
    v_mul_f32 v28, v29, v29
    v_sub_f32 v29, v13, v30
    v_fmac_f32 v28, v29, v29
    v_sub_f32 v29, v14, v30
    v_fmac_f32 v28, v29, v29
    v_sub_f32 v29, v15, v30
    v_fmac_f32 v28, v29, v29
    v_sub_f32 v29, v16, v30
    v_fmac_f32 v28, v29, v29
    v_sub_f32 v29, v17, v30
    v_fmac_f32 v28, v29, v29
    v_sub_f32 v29, v18, v30
    v_fmac_f32 v28, v29, v29
    v_sub_f32 v29, v19, v30
    v_fmac_f32 v28, v29, v29
    v_sub_f32 v29, v20, v30
    v_fmac_f32 v28, v29, v29
    v_sub_f32 v29, v21, v30
    v_fmac_f32 v28, v29, v29
    v_sub_f32 v29, v22, v30
    v_fmac_f32 v28, v29, v29
    v_sub_f32 v29, v23, v30
    v_fmac_f32 v28, v29, v29
    v_sub_f32 v29, v24, v30
    v_fmac_f32 v28, v29, v29
    v_sub_f32 v29, v25, v30
    v_fmac_f32 v28, v29, v29
    v_sub_f32 v29, v26, v30
    v_fmac_f32 v28, v29, v29
    v_sub_f32 v29, v27, v30
    v_fmac_f32 v28, v29, v29
    ds_swizzle_b32 v29, v28 offset:0x41f
    s_waitcnt lgkmcnt(0)
    v_add_f32 v28, v28, v29
    ds_swizzle_b32 v29, v28 offset:0x81f
    s_waitcnt lgkmcnt(0)
    v_add_f32 v28, v28, v29
    ds_swizzle_b32 v29, v28 offset:0x101f
    s_waitcnt lgkmcnt(0)
    v_add_f32 v28, v28, v29
    ds_swizzle_b32 v29, v28 offset:0x201f
    s_waitcnt lgkmcnt(0)
    v_add_f32 v28, v28, v29
    ds_swizzle_b32 v29, v28 offset:0x401f
    s_waitcnt lgkmcnt(0)
    v_add_f32 v28, v28, v29
    s_nop 1
    v_readlane_b32 s17, v28, 32
    s_nop 3
    v_add_f32 v28, s17, v28
    s_nop 1
    v_readlane_b32 s17, v28, 0
    s_nop 3
    v_mov_b32 v28, 0x3a800000
    v_mul_f32 v31, s17, v28
    v_cvt_pk_bf16_f32 v30, v30, v30
    v_lshlrev_b32 v30, 16, v30
    v_cvt_pk_bf16_f32 v31, v31, v31
    v_lshlrev_b32 v31, 16, v31
    v_add_f32 v31, 0x3727c5ac, v31
    v_cvt_pk_bf16_f32 v31, v31, v31
    v_lshlrev_b32 v31, 16, v31
    v_sqrt_f32 v31, v31
    s_nop 0
    v_cvt_pk_bf16_f32 v31, v31, v31
    v_lshlrev_b32 v31, 16, v31
    v_rcp_f32 v31, v31
    s_nop 0
    v_sub_f32 v29, v12, v30
    v_cvt_pk_bf16_f32 v29, v29, v29
    v_lshlrev_b32 v29, 16, v29
    v_mul_f32 v12, v29, v31
    v_sub_f32 v29, v13, v30
    v_cvt_pk_bf16_f32 v29, v29, v29
    v_lshlrev_b32 v29, 16, v29
    v_mul_f32 v13, v29, v31
    v_sub_f32 v29, v14, v30
    v_cvt_pk_bf16_f32 v29, v29, v29
    v_lshlrev_b32 v29, 16, v29
    v_mul_f32 v14, v29, v31
    v_sub_f32 v29, v15, v30
    v_cvt_pk_bf16_f32 v29, v29, v29
    v_lshlrev_b32 v29, 16, v29
    v_mul_f32 v15, v29, v31
    v_sub_f32 v29, v16, v30
    v_cvt_pk_bf16_f32 v29, v29, v29
    v_lshlrev_b32 v29, 16, v29
    v_mul_f32 v16, v29, v31
    v_sub_f32 v29, v17, v30
    v_cvt_pk_bf16_f32 v29, v29, v29
    v_lshlrev_b32 v29, 16, v29
    v_mul_f32 v17, v29, v31
    v_sub_f32 v29, v18, v30
    v_cvt_pk_bf16_f32 v29, v29, v29
    v_lshlrev_b32 v29, 16, v29
    v_mul_f32 v18, v29, v31
    v_sub_f32 v29, v19, v30
    v_cvt_pk_bf16_f32 v29, v29, v29
    v_lshlrev_b32 v29, 16, v29
    v_mul_f32 v19, v29, v31
    v_sub_f32 v29, v20, v30
    v_cvt_pk_bf16_f32 v29, v29, v29
    v_lshlrev_b32 v29, 16, v29
    v_mul_f32 v20, v29, v31
    v_sub_f32 v29, v21, v30
    v_cvt_pk_bf16_f32 v29, v29, v29
    v_lshlrev_b32 v29, 16, v29
    v_mul_f32 v21, v29, v31
    v_sub_f32 v29, v22, v30
    v_cvt_pk_bf16_f32 v29, v29, v29
    v_lshlrev_b32 v29, 16, v29
    v_mul_f32 v22, v29, v31
    v_sub_f32 v29, v23, v30
    v_cvt_pk_bf16_f32 v29, v29, v29
    v_lshlrev_b32 v29, 16, v29
    v_mul_f32 v23, v29, v31
    v_sub_f32 v29, v24, v30
    v_cvt_pk_bf16_f32 v29, v29, v29
    v_lshlrev_b32 v29, 16, v29
    v_mul_f32 v24, v29, v31
    v_sub_f32 v29, v25, v30
    v_cvt_pk_bf16_f32 v29, v29, v29
    v_lshlrev_b32 v29, 16, v29
    v_mul_f32 v25, v29, v31
    v_sub_f32 v29, v26, v30
    v_cvt_pk_bf16_f32 v29, v29, v29
    v_lshlrev_b32 v29, 16, v29
    v_mul_f32 v26, v29, v31
    v_sub_f32 v29, v27, v30
    v_cvt_pk_bf16_f32 v29, v29, v29
    v_lshlrev_b32 v29, 16, v29
    v_mul_f32 v27, v29, v31
    v_cvt_pk_bf16_f32 v4, v12, v13
    v_cvt_pk_bf16_f32 v5, v14, v15
    v_cvt_pk_bf16_f32 v6, v16, v17
    v_cvt_pk_bf16_f32 v7, v18, v19
    v_cvt_pk_bf16_f32 v8, v20, v21
    v_cvt_pk_bf16_f32 v9, v22, v23
    v_cvt_pk_bf16_f32 v10, v24, v25
    v_cvt_pk_bf16_f32 v11, v26, v27
    s_mov_b32 s3, 4194304
    buffer_store_dwordx4 v[4:7], v1, s[12:15], s3 offen
    buffer_store_dwordx4 v[8:11], v1, s[12:15], s3 offen offset:1024
ln_done:
    s_endpgm
.globl rec_kernel
.p2align 8
.type rec_kernel,@function
rec_kernel:
    s_cmp_ge_u32 s2, 256
    s_cbranch_scc1 rec_done
    s_cmp_ge_u32 s2, 128
    s_cbranch_scc1 rec_worker
    s_load_dwordx2 s[4:5], s[0:1], 112
    s_load_dwordx2 s[6:7], s[0:1], 8
    s_load_dwordx4 s[24:27], s[0:1], 16
    s_load_dwordx4 s[28:31], s[0:1], 32
    s_and_b32 s16, s2, 7
    s_lshl_b32 s16, s16, 2
    s_lshr_b32 s17, s2, 5
    s_add_u32 s16, s16, s17
    s_bfe_u32 s17, s2, 0x20003
    s_mov_b32 s20, 2097152
    v_and_b32 v1, 63, v0
    v_lshrrev_b32 v2, 6, v0
    v_and_b32 v3, 15, v1
    v_lshrrev_b32 v4, 4, v1
    s_waitcnt lgkmcnt(0)
    s_mov_b32 s8, s4
    s_mov_b32 s9, s5
    s_mov_b32 s10, 268435456
    s_mov_b32 s11, 0x00020000
    s_getreg_b32 s21, hwreg(HW_REG_XCC_ID)
    s_and_b32 s21, s21, 15
    v_mov_b32 v5, s21
    s_lshl_b32 s22, s16, 4
    s_lshl_b32 s23, s17, 2
    s_add_u32 s23, s23, s22
    s_add_u32 s23, s23, 197132288
    v_mov_b32 v6, s23
    buffer_store_dword v5, v6, s[8:11], 0 offen sc1
    s_add_u32 s22, s22, 197132288
    v_mov_b32 v6, s22
    s_mov_b32 s19, 0
rec_xw:
    buffer_load_dwordx4 v[8:11], v6, s[8:11], 0 offen sc1
    s_waitcnt vmcnt(0)
    v_max_u32 v7, v8, v9
    v_max3_u32 v7, v7, v10, v11
    v_cmp_eq_u32 vcc, -1, v7
    s_cbranch_vccz rec_xd
    s_add_u32 s19, s19, 1
    s_cmp_lt_u32 s19, s20
    s_cbranch_scc1 rec_xw
    s_mov_b32 s20, 0
rec_xd:
    v_xor_b32 v9, v8, v9
    v_xor_b32 v10, v8, v10
    v_xor_b32 v11, v8, v11
    v_or3_b32 v9, v9, v10, v11
    s_nop 1
    v_readfirstlane_b32 s34, v9
    v_lshlrev_b32 v5, 7, v2
    v_lshrrev_b32 v6, 2, v1
    v_add_u32 v5, v5, v6
    v_lshlrev_b32 v5, 13, v5
    v_and_b32 v6, 3, v1
    v_lshlrev_b32 v6, 4, v6
    s_lshl_b32 s21, s16, 8
    s_lshl_b32 s22, s17, 6
    s_add_u32 s21, s21, s22
    v_add3_u32 v5, v5, v6, s21
    v_lshlrev_b32 v7, 13, v2
    v_lshlrev_b32 v6, 4, v1
    v_add_u32 v7, v7, v6
    v_lshlrev_b32 v8, 3, v4
    v_lshrrev_b32 v6, 2, v3
    v_add_u32 v8, v8, v6
    v_lshlrev_b32 v8, 6, v8
    v_and_b32 v6, 3, v1
    v_lshlrev_b32 v6, 3, v6
    v_add_u32 v8, v8, v6
    v_lshlrev_b32 v6, 13, v2
    v_add_u32 v8, v8, v6
    s_mov_b32 s12, s24
    s_mov_b32 s13, s25
    s_mov_b32 s14, 8388608
    s_mov_b32 s15, 0x00020000
    s_mov_b32 s21, 0
    buffer_load_dwordx4 v[32:35], v5, s[12:15], s21 offen
    s_mov_b32 s21, 131072
    buffer_load_dwordx4 v[36:39], v5, s[12:15], s21 offen
    s_mov_b32 s21, 262144
    buffer_load_dwordx4 v[40:43], v5, s[12:15], s21 offen
    s_mov_b32 s21, 393216
    buffer_load_dwordx4 v[44:47], v5, s[12:15], s21 offen
    s_mov_b32 s21, 524288
    buffer_load_dwordx4 v[48:51], v5, s[12:15], s21 offen
    s_mov_b32 s21, 655360
    buffer_load_dwordx4 v[52:55], v5, s[12:15], s21 offen
    s_mov_b32 s21, 786432
    buffer_load_dwordx4 v[56:59], v5, s[12:15], s21 offen
    s_mov_b32 s21, 917504
    buffer_load_dwordx4 v[60:63], v5, s[12:15], s21 offen
    s_waitcnt vmcnt(0)
    ds_write_b128 v7, v[32:35] offset:0
    ds_write_b128 v7, v[36:39] offset:1024
    ds_write_b128 v7, v[40:43] offset:2048
    ds_write_b128 v7, v[44:47] offset:3072
    ds_write_b128 v7, v[48:51] offset:4096
    ds_write_b128 v7, v[52:55] offset:5120
    ds_write_b128 v7, v[56:59] offset:6144
    ds_write_b128 v7, v[60:63] offset:7168
    s_waitcnt lgkmcnt(0)
    ds_read_b64_tr_b16 v[128:129], v8 offset:0
    ds_read_b64_tr_b16 v[130:131], v8 offset:256
    ds_read_b64_tr_b16 v[132:133], v8 offset:2048
    ds_read_b64_tr_b16 v[134:135], v8 offset:2304
    ds_read_b64_tr_b16 v[136:137], v8 offset:4096
    ds_read_b64_tr_b16 v[138:139], v8 offset:4352
    ds_read_b64_tr_b16 v[140:141], v8 offset:6144
    ds_read_b64_tr_b16 v[142:143], v8 offset:6400
    ds_read_b64_tr_b16 v[144:145], v8 offset:32
    ds_read_b64_tr_b16 v[146:147], v8 offset:288
    ds_read_b64_tr_b16 v[148:149], v8 offset:2080
    ds_read_b64_tr_b16 v[150:151], v8 offset:2336
    ds_read_b64_tr_b16 v[152:153], v8 offset:4128
    ds_read_b64_tr_b16 v[154:155], v8 offset:4384
    ds_read_b64_tr_b16 v[156:157], v8 offset:6176
    ds_read_b64_tr_b16 v[158:159], v8 offset:6432
    s_waitcnt lgkmcnt(0)
    s_mov_b32 s12, s26
    s_mov_b32 s13, s27
    s_mov_b32 s14, 8388608
    s_mov_b32 s15, 0x00020000
    s_mov_b32 s21, 0
    buffer_load_dwordx4 v[32:35], v5, s[12:15], s21 offen
    s_mov_b32 s21, 131072
    buffer_load_dwordx4 v[36:39], v5, s[12:15], s21 offen
    s_mov_b32 s21, 262144
    buffer_load_dwordx4 v[40:43], v5, s[12:15], s21 offen
    s_mov_b32 s21, 393216
    buffer_load_dwordx4 v[44:47], v5, s[12:15], s21 offen
    s_mov_b32 s21, 524288
    buffer_load_dwordx4 v[48:51], v5, s[12:15], s21 offen
    s_mov_b32 s21, 655360
    buffer_load_dwordx4 v[52:55], v5, s[12:15], s21 offen
    s_mov_b32 s21, 786432
    buffer_load_dwordx4 v[56:59], v5, s[12:15], s21 offen
    s_mov_b32 s21, 917504
    buffer_load_dwordx4 v[60:63], v5, s[12:15], s21 offen
    s_waitcnt vmcnt(0)
    ds_write_b128 v7, v[32:35] offset:0
    ds_write_b128 v7, v[36:39] offset:1024
    ds_write_b128 v7, v[40:43] offset:2048
    ds_write_b128 v7, v[44:47] offset:3072
    ds_write_b128 v7, v[48:51] offset:4096
    ds_write_b128 v7, v[52:55] offset:5120
    ds_write_b128 v7, v[56:59] offset:6144
    ds_write_b128 v7, v[60:63] offset:7168
    s_waitcnt lgkmcnt(0)
    ds_read_b64_tr_b16 v[160:161], v8 offset:0
    ds_read_b64_tr_b16 v[162:163], v8 offset:256
    ds_read_b64_tr_b16 v[164:165], v8 offset:2048
    ds_read_b64_tr_b16 v[166:167], v8 offset:2304
    ds_read_b64_tr_b16 v[168:169], v8 offset:4096
    ds_read_b64_tr_b16 v[170:171], v8 offset:4352
    ds_read_b64_tr_b16 v[172:173], v8 offset:6144
    ds_read_b64_tr_b16 v[174:175], v8 offset:6400
    ds_read_b64_tr_b16 v[176:177], v8 offset:32
    ds_read_b64_tr_b16 v[178:179], v8 offset:288
    ds_read_b64_tr_b16 v[180:181], v8 offset:2080
    ds_read_b64_tr_b16 v[182:183], v8 offset:2336
    ds_read_b64_tr_b16 v[184:185], v8 offset:4128
    ds_read_b64_tr_b16 v[186:187], v8 offset:4384
    ds_read_b64_tr_b16 v[188:189], v8 offset:6176
    ds_read_b64_tr_b16 v[190:191], v8 offset:6432
    s_waitcnt lgkmcnt(0)
    s_mov_b32 s12, s28
    s_mov_b32 s13, s29
    s_mov_b32 s14, 8388608
    s_mov_b32 s15, 0x00020000
    s_mov_b32 s21, 0
    buffer_load_dwordx4 v[32:35], v5, s[12:15], s21 offen
    s_mov_b32 s21, 131072
    buffer_load_dwordx4 v[36:39], v5, s[12:15], s21 offen
    s_mov_b32 s21, 262144
    buffer_load_dwordx4 v[40:43], v5, s[12:15], s21 offen
    s_mov_b32 s21, 393216
    buffer_load_dwordx4 v[44:47], v5, s[12:15], s21 offen
    s_mov_b32 s21, 524288
    buffer_load_dwordx4 v[48:51], v5, s[12:15], s21 offen
    s_mov_b32 s21, 655360
    buffer_load_dwordx4 v[52:55], v5, s[12:15], s21 offen
    s_mov_b32 s21, 786432
    buffer_load_dwordx4 v[56:59], v5, s[12:15], s21 offen
    s_mov_b32 s21, 917504
    buffer_load_dwordx4 v[60:63], v5, s[12:15], s21 offen
    s_waitcnt vmcnt(0)
    ds_write_b128 v7, v[32:35] offset:0
    ds_write_b128 v7, v[36:39] offset:1024
    ds_write_b128 v7, v[40:43] offset:2048
    ds_write_b128 v7, v[44:47] offset:3072
    ds_write_b128 v7, v[48:51] offset:4096
    ds_write_b128 v7, v[52:55] offset:5120
    ds_write_b128 v7, v[56:59] offset:6144
    ds_write_b128 v7, v[60:63] offset:7168
    s_waitcnt lgkmcnt(0)
    ds_read_b64_tr_b16 v[192:193], v8 offset:0
    ds_read_b64_tr_b16 v[194:195], v8 offset:256
    ds_read_b64_tr_b16 v[196:197], v8 offset:2048
    ds_read_b64_tr_b16 v[198:199], v8 offset:2304
    ds_read_b64_tr_b16 v[200:201], v8 offset:4096
    ds_read_b64_tr_b16 v[202:203], v8 offset:4352
    ds_read_b64_tr_b16 v[204:205], v8 offset:6144
    ds_read_b64_tr_b16 v[206:207], v8 offset:6400
    ds_read_b64_tr_b16 v[208:209], v8 offset:32
    ds_read_b64_tr_b16 v[210:211], v8 offset:288
    ds_read_b64_tr_b16 v[212:213], v8 offset:2080
    ds_read_b64_tr_b16 v[214:215], v8 offset:2336
    ds_read_b64_tr_b16 v[216:217], v8 offset:4128
    ds_read_b64_tr_b16 v[218:219], v8 offset:4384
    ds_read_b64_tr_b16 v[220:221], v8 offset:6176
    ds_read_b64_tr_b16 v[222:223], v8 offset:6432
    s_waitcnt lgkmcnt(0)
    s_mov_b32 s12, s30
    s_mov_b32 s13, s31
    s_mov_b32 s14, 8388608
    s_mov_b32 s15, 0x00020000
    v_lshrrev_b32 v5, 2, v1
    s_lshl_b32 s21, s16, 7
    v_add_u32 v5, s21, v5
    v_lshlrev_b32 v5, 11, v5
    v_and_b32 v6, 3, v1
    v_lshlrev_b32 v6, 4, v6
    v_lshlrev_b32 v9, 6, v2
    s_lshl_b32 s21, s17, 9
    v_add3_u32 v5, v5, v6, s21
    v_add_u32 v5, v5, v9
    s_mov_b32 s21, 0
    buffer_load_dwordx4 v[32:35], v5, s[12:15], s21 offen
    s_mov_b32 s21, 32768
    buffer_load_dwordx4 v[36:39], v5, s[12:15], s21 offen
    s_mov_b32 s21, 65536
    buffer_load_dwordx4 v[40:43], v5, s[12:15], s21 offen
    s_mov_b32 s21, 98304
    buffer_load_dwordx4 v[44:47], v5, s[12:15], s21 offen
    s_mov_b32 s21, 131072
    buffer_load_dwordx4 v[48:51], v5, s[12:15], s21 offen
    s_mov_b32 s21, 163840
    buffer_load_dwordx4 v[52:55], v5, s[12:15], s21 offen
    s_mov_b32 s21, 196608
    buffer_load_dwordx4 v[56:59], v5, s[12:15], s21 offen
    s_mov_b32 s21, 229376
    buffer_load_dwordx4 v[60:63], v5, s[12:15], s21 offen
    s_waitcnt vmcnt(0)
    ds_write_b128 v7, v[32:35] offset:0
    ds_write_b128 v7, v[36:39] offset:1024
    ds_write_b128 v7, v[40:43] offset:2048
    ds_write_b128 v7, v[44:47] offset:3072
    ds_write_b128 v7, v[48:51] offset:4096
    ds_write_b128 v7, v[52:55] offset:5120
    ds_write_b128 v7, v[56:59] offset:6144
    ds_write_b128 v7, v[60:63] offset:7168
    v_lshlrev_b32 v8, 2, v4
    v_lshrrev_b32 v6, 2, v3
    v_add_u32 v8, v8, v6
    v_lshlrev_b32 v8, 6, v8
    v_and_b32 v6, 3, v1
    v_lshlrev_b32 v6, 3, v6
    v_add_u32 v8, v8, v6
    v_lshlrev_b32 v6, 13, v2
    v_add_u32 v8, v8, v6
    s_waitcnt lgkmcnt(0)
    ds_read_b64_tr_b16 v[224:225], v8 offset:0
    ds_read_b64_tr_b16 v[226:227], v8 offset:1024
    ds_read_b64_tr_b16 v[228:229], v8 offset:2048
    ds_read_b64_tr_b16 v[230:231], v8 offset:3072
    ds_read_b64_tr_b16 v[232:233], v8 offset:4096
    ds_read_b64_tr_b16 v[234:235], v8 offset:5120
    ds_read_b64_tr_b16 v[236:237], v8 offset:6144
    ds_read_b64_tr_b16 v[238:239], v8 offset:7168
    ds_read_b64_tr_b16 v[240:241], v8 offset:32
    ds_read_b64_tr_b16 v[242:243], v8 offset:1056
    ds_read_b64_tr_b16 v[244:245], v8 offset:2080
    ds_read_b64_tr_b16 v[246:247], v8 offset:3104
    ds_read_b64_tr_b16 v[248:249], v8 offset:4128
    ds_read_b64_tr_b16 v[250:251], v8 offset:5152
    ds_read_b64_tr_b16 v[252:253], v8 offset:6176
    ds_read_b64_tr_b16 v[254:255], v8 offset:7200
    s_waitcnt lgkmcnt(0)
    s_barrier
    v_lshlrev_b32 v5, 11, v3
    v_lshlrev_b32 v6, 8, v2
    v_lshlrev_b32 v7, 4, v4
    v_add3_u32 v5, v5, v6, v7
    v_lshlrev_b32 v28, 4, v2
    v_add_u32 v28, v28, v4
    v_lshlrev_b32 v28, 3, v28
    v_add_u32 v28, v28, v3
    v_lshlrev_b32 v28, 4, v28
    v_lshrrev_b32 v6, 4, v0
    v_lshlrev_b32 v6, 13, v6
    v_and_b32 v7, 15, v0
    v_lshlrev_b32 v7, 4, v7
    s_lshl_b32 s21, s16, 8
    v_add3_u32 v6, v6, v7, s21
    v_lshrrev_b32 v7, 4, v0
    v_mul_u32_u24 v7, 272, v7
    v_and_b32 v8, 15, v0
    v_lshlrev_b32 v8, 4, v8
    v_add_u32 v7, v7, v8
    v_lshlrev_b32 v8, 4, v0
    s_lshl_b32 s21, s16, 13
    v_add_u32 v8, s21, v8
    v_lshrrev_b32 v9, 2, v0
    v_mul_u32_u24 v9, 72, v9
    v_and_b32 v10, 3, v0
    v_lshlrev_b32 v10, 4, v10
    v_add_u32 v9, v9, v10
    v_add_u32 v9, 8704, v9
    v_mul_u32_u24 v10, 384, v2
    v_add_u32 v10, v10, v1
    v_lshlrev_b32 v10, 4, v10
    v_add_u32 v10, 28416, v10
    v_lshrrev_b32 v11, 7, v0
    v_lshlrev_b32 v11, 1, v11
    v_bfe_u32 v12, v0, 3, 1
    v_add_u32 v11, v11, v12
    v_lshlrev_b32 v11, 6, v11
    v_bfe_u32 v12, v0, 1, 2
    v_lshlrev_b32 v12, 4, v12
    v_add_u32 v11, v11, v12
    v_bfe_u32 v12, v0, 4, 3
    v_add_u32 v11, v11, v12
    v_lshlrev_b32 v11, 4, v11
    v_and_b32 v12, 1, v0
    v_lshlrev_b32 v12, 3, v12
    v_add_u32 v11, v11, v12
    v_add_u32 v11, 28416, v11
    v_add_u32 v12, 4, v11
    v_subrev_u32 v14, 0x100, v0
    v_bfe_u32 v15, v14, 7, 1
    v_add_u32 v15, 4, v15
    v_lshlrev_b32 v15, 6, v15
    v_bfe_u32 v16, v14, 5, 2
    v_lshlrev_b32 v16, 4, v16
    v_add_u32 v15, v15, v16
    v_and_b32 v16, 7, v14
    v_add_u32 v15, v15, v16
    v_lshlrev_b32 v15, 4, v15
    v_bfe_u32 v16, v14, 3, 2
    v_lshlrev_b32 v16, 2, v16
    v_add_u32 v15, v15, v16
    v_add_u32 v15, 28416, v15
    v_lshlrev_b32 v13, 2, v0
    v_lshrrev_b32 v16, 1, v14
    v_lshlrev_b32 v16, 2, v16
    v_add_u32 v16, 0x400, v16
    v_cmp_le_u32 vcc, 0x100, v0
    s_nop 1
    v_cndmask_b32 v11, v11, v15, vcc
    v_cndmask_b32 v13, v13, v16, vcc
    s_mul_i32 s21, s17, 1536
    v_add_u32 v13, s21, v13
    v_lshlrev_b32 v14, 4, v0
    v_mul_u32_u24 v18, 683, v0
    v_lshrrev_b32 v18, 16, v18
    v_mul_u32_u24 v19, 96, v18
    v_sub_u32 v19, v0, v19
    v_lshrrev_b32 v20, 5, v19
    v_and_b32 v21, 31, v19
    v_lshlrev_b32 v22, 3, v20
    v_lshrrev_b32 v23, 2, v21
    v_add_u32 v22, v22, v23
    v_mul_u32_u24 v22, 272, v22
    v_lshlrev_b32 v23, 6, v18
    v_add_u32 v22, v22, v23
    v_and_b32 v23, 3, v21
    v_lshlrev_b32 v23, 4, v23
    v_add_u32 v22, v22, v23
    v_add_u32 v22, 17920, v22
    v_lshlrev_b32 v23, 5, v18
    v_add_u32 v23, v23, v21
    v_lshlrev_b32 v23, 4, v23
    v_add_u32 v23, 22272, v23
    v_cmp_eq_u32 vcc, 2, v20
    s_nop 1
    v_cndmask_b32 v15, v22, v23, vcc
    v_mul_u32_u24 v17, 272, v3
    v_lshlrev_b32 v18, 4, v4
    v_add_u32 v17, v17, v18
    v_lshlrev_b32 v18, 4, v2
    v_add_u32 v18, v18, v3
    v_lshlrev_b32 v19, 4, v18
    v_mul_u32_u24 v18, 72, v18
    v_lshlrev_b32 v20, 3, v4
    v_add_u32 v18, v18, v20
    v_add_u32 v18, 8704, v18
    v_and_b32 v20, 1, v4
    v_lshlrev_b32 v20, 3, v20
    v_add_u32 v19, v19, v20
    v_add_u32 v19, 22272, v19
    v_lshlrev_b32 v16, 3, v0
    v_add_u32 v16, 24320, v16
    v_lshlrev_b32 v20, 3, v1
    v_add_u32 v20, 24320, v20
    v_lshlrev_b32 v22, 3, v2
    v_add_u32 v22, v22, v4
    v_lshlrev_b32 v22, 3, v22
    v_add_u32 v22, v22, v3
    v_lshlrev_b32 v22, 4, v22
    s_lshl_b32 s21, s17, 5
    s_add_u32 s21, s21, s16
    s_lshl_b32 s21, s21, 13
    v_add_u32 v22, s21, v22
    v_lshlrev_b32 v23, 13, v4
    v_lshlrev_b32 v24, 4, v3
    s_lshl_b32 s21, s17, 18
    s_lshl_b32 s22, s16, 8
    s_add_u32 s21, s21, s22
    v_add3_u32 v23, v23, v24, s21
    v_and_b32 v24, 7, v1
    v_lshlrev_b32 v24, 4, v24
    v_bfe_u32 v25, v1, 3, 1
    v_lshlrev_b32 v25, 3, v25
    s_lshl_b32 s21, s17, 12
    s_lshl_b32 s22, s16, 7
    s_add_u32 s21, s21, s22
    v_add3_u32 v24, v24, v25, s21
    v_mov_b32 v26, -1
    v_mov_b32 v25, 0x7fc07fc0
    s_mov_b32 s18, 0
    s_mov_b32 s12, s6
    s_mov_b32 s13, s7
    s_mov_b32 s14, 16384
    s_mov_b32 s15, 0x00020000
    v_cmp_gt_u32 vcc, 8, v3
    s_and_saveexec_b64 s[32:33], vcc
    buffer_load_dwordx4 v[32:35], v5, s[12:15], 0 offen offset:0
    buffer_load_dwordx4 v[36:39], v5, s[12:15], 0 offen offset:64
    buffer_load_dwordx4 v[40:43], v5, s[12:15], 0 offen offset:128
    buffer_load_dwordx4 v[44:47], v5, s[12:15], 0 offen offset:192
    s_mov_b64 exec, s[32:33]
rec_step:
    s_and_b32 s21, s18, 3
    s_cmp_lg_u32 s21, 0
    s_cbranch_scc1 rec_kvok
    s_add_u32 s21, s18, 117440512
    v_mov_b32 v27, s21
    s_mov_b32 s19, 0
rec_kvw:
    buffer_load_dword v29, v27, s[8:11], 0 offen sc1
    s_waitcnt vmcnt(0)
    v_cmp_gt_u32 vcc, 64, v29
    s_cbranch_vccz rec_kvok
    s_sleep 32
    s_add_u32 s19, s19, 1
    s_cmp_lt_u32 s19, 0x80000
    s_cbranch_scc1 rec_kvw
rec_kvok:
    s_lshl_b32 s21, s18, 18
    s_add_u32 s21, s21, 25165824
    buffer_load_dwordx4 v[112:115], v6, s[8:11], s21 offen sc1
    s_lshl_b32 s21, s18, 18
    s_add_u32 s21, s21, 41943040
    buffer_load_dwordx4 v[120:123], v8, s[8:11], s21 offen sc1
    s_cmp_eq_u32 s18, 0
    s_cbranch_scc1 rec_p1s
    s_lshl_b32 s21, s18, 14
    s_add_u32 s21, s21, 100663296
    s_mov_b32 s19, 0
    v_cmp_gt_u32 vcc, 8, v3
    s_and_saveexec_b64 s[32:33], vcc
rec_p1:
    buffer_load_dwordx4 v[32:35], v28, s[8:11], s21 offen offset:0 sc1
    buffer_load_dwordx4 v[36:39], v28, s[8:11], s21 offen offset:512 sc1
    buffer_load_dwordx4 v[40:43], v28, s[8:11], s21 offen offset:1024 sc1
    buffer_load_dwordx4 v[44:47], v28, s[8:11], s21 offen offset:1536 sc1
    s_waitcnt vmcnt(0)
    v_max_u32 v27, v32, v33
    v_max3_u32 v27, v27, v34, v35
    v_max3_u32 v27, v27, v36, v37
    v_max3_u32 v27, v27, v38, v39
    v_max3_u32 v27, v27, v40, v41
    v_max3_u32 v27, v27, v42, v43
    v_max3_u32 v27, v27, v44, v45
    v_max3_u32 v27, v27, v46, v47
    v_cmp_eq_u32 vcc, -1, v27
    s_cbranch_vccz rec_p1d
    s_add_u32 s19, s19, 1
    s_cmp_lt_u32 s19, s20
    s_cbranch_scc1 rec_p1
    s_mov_b32 s20, 0
rec_p1d:
    s_mov_b64 exec, s[32:33]
rec_p1s:
    s_waitcnt vmcnt(0)
    v_mfma_f32_16x16x32_bf16 v[64:67], v[128:131], v[32:35], 0
    v_mfma_f32_16x16x32_bf16 v[68:71], v[144:147], v[32:35], 0
    v_mfma_f32_16x16x32_bf16 v[72:75], v[160:163], v[32:35], 0
    v_mfma_f32_16x16x32_bf16 v[76:79], v[176:179], v[32:35], 0
    v_mfma_f32_16x16x32_bf16 v[80:83], v[192:195], v[32:35], 0
    v_mfma_f32_16x16x32_bf16 v[84:87], v[208:211], v[32:35], 0
    v_mfma_f32_16x16x32_bf16 v[64:67], v[132:135], v[36:39], v[64:67]
    v_mfma_f32_16x16x32_bf16 v[68:71], v[148:151], v[36:39], v[68:71]
    v_mfma_f32_16x16x32_bf16 v[72:75], v[164:167], v[36:39], v[72:75]
    v_mfma_f32_16x16x32_bf16 v[76:79], v[180:183], v[36:39], v[76:79]
    v_mfma_f32_16x16x32_bf16 v[80:83], v[196:199], v[36:39], v[80:83]
    v_mfma_f32_16x16x32_bf16 v[84:87], v[212:215], v[36:39], v[84:87]
    v_mfma_f32_16x16x32_bf16 v[64:67], v[136:139], v[40:43], v[64:67]
    v_mfma_f32_16x16x32_bf16 v[68:71], v[152:155], v[40:43], v[68:71]
    v_mfma_f32_16x16x32_bf16 v[72:75], v[168:171], v[40:43], v[72:75]
    v_mfma_f32_16x16x32_bf16 v[76:79], v[184:187], v[40:43], v[76:79]
    v_mfma_f32_16x16x32_bf16 v[80:83], v[200:203], v[40:43], v[80:83]
    v_mfma_f32_16x16x32_bf16 v[84:87], v[216:219], v[40:43], v[84:87]
    v_mfma_f32_16x16x32_bf16 v[64:67], v[140:143], v[44:47], v[64:67]
    v_mfma_f32_16x16x32_bf16 v[68:71], v[156:159], v[44:47], v[68:71]
    v_mfma_f32_16x16x32_bf16 v[72:75], v[172:175], v[44:47], v[72:75]
    v_mfma_f32_16x16x32_bf16 v[76:79], v[188:191], v[44:47], v[76:79]
    v_mfma_f32_16x16x32_bf16 v[80:83], v[204:207], v[44:47], v[80:83]
    v_mfma_f32_16x16x32_bf16 v[84:87], v[220:223], v[44:47], v[84:87]
    ds_write_b128 v7, v[112:115]
    ds_write_b128 v9, v[120:123]
    s_nop 7
    ds_write_b128 v10, v[64:67] offset:0
    ds_write_b128 v10, v[68:71] offset:1024
    ds_write_b128 v10, v[72:75] offset:2048
    ds_write_b128 v10, v[76:79] offset:3072
    ds_write_b128 v10, v[80:83] offset:4096
    ds_write_b128 v10, v[84:87] offset:5120
    s_waitcnt lgkmcnt(0)
    s_barrier
    s_mul_i32 s21, s18, 196608
    s_mul_i32 s22, s16, 6144
    s_add_u32 s21, s21, s22
    s_add_u32 s35, s21, 184549376
    s_add_u32 s21, s21, 102760448
    v_readfirstlane_b32 s22, v2
    s_cmp_ge_u32 s22, 4
    s_cbranch_scc1 rec_pubv
    ds_read_b64 v[32:33], v11 offset:0
    ds_read_b64 v[34:35], v11 offset:6144
    ds_read_b64 v[36:37], v11 offset:12288
    ds_read_b64 v[38:39], v11 offset:18432
    ds_read_b64 v[40:41], v11 offset:24576
    ds_read_b64 v[42:43], v11 offset:30720
    ds_read_b64 v[44:45], v11 offset:36864
    ds_read_b64 v[46:47], v11 offset:43008
    s_waitcnt lgkmcnt(0)
    v_add_f32 v32, v32, v34
    v_add_f32 v33, v33, v35
    v_add_f32 v36, v36, v38
    v_add_f32 v37, v37, v39
    v_add_f32 v40, v40, v42
    v_add_f32 v41, v41, v43
    v_add_f32 v44, v44, v46
    v_add_f32 v45, v45, v47
    v_add_f32 v32, v32, v36
    v_add_f32 v33, v33, v37
    v_add_f32 v40, v40, v44
    v_add_f32 v41, v41, v45
    v_add_f32 v32, v32, v40
    v_add_f32 v33, v33, v41
    v_cvt_pk_bf16_f32 v32, v32, v33
    v_cmp_eq_u32 vcc, -1, v32
    s_nop 1
    v_cndmask_b32 v32, v32, v25, vcc
    buffer_store_dword v32, v13, s[8:11], s35 offen
    buffer_store_dword v32, v13, s[8:11], s21 offen sc1
    s_branch rec_pubd
rec_pubv:
    ds_read_b32 v32, v11 offset:0
    ds_read_b32 v33, v11 offset:6144
    ds_read_b32 v34, v11 offset:12288
    ds_read_b32 v35, v11 offset:18432
    ds_read_b32 v36, v11 offset:24576
    ds_read_b32 v37, v11 offset:30720
    ds_read_b32 v38, v11 offset:36864
    ds_read_b32 v39, v11 offset:43008
    s_waitcnt lgkmcnt(0)
    v_add_f32 v32, v32, v33
    v_add_f32 v34, v34, v35
    v_add_f32 v36, v36, v37
    v_add_f32 v38, v38, v39
    v_add_f32 v32, v32, v34
    v_add_f32 v36, v36, v38
    v_add_f32 v32, v32, v36
    s_nop 1
    v_mov_b32_dpp v33, v32 quad_perm:[1,0,3,2] row_mask:0xf bank_mask:0xf
    v_cvt_pk_bf16_f32 v32, v32, v33
    v_cmp_eq_u32 vcc, -1, v32
    s_nop 1
    v_cndmask_b32 v32, v32, v25, vcc
    v_and_b32 v33, 1, v1
    v_cmp_eq_u32 vcc, 0, v33
    s_and_saveexec_b64 s[32:33], vcc
    buffer_store_dword v32, v13, s[8:11], s35 offen
    buffer_store_dword v32, v13, s[8:11], s21 offen sc1
    s_mov_b64 exec, s[32:33]
rec_pubd:
    s_cmp_eq_u32 s34, 0
    s_cselect_b32 s21, s35, s21
    ds_read_b128 v[48:51], v17 offset:0
    ds_read_b128 v[64:67], v17 offset:4352
    ds_read_b128 v[52:55], v17 offset:64
    ds_read_b128 v[68:71], v17 offset:4416
    ds_read_b128 v[56:59], v17 offset:128
    ds_read_b128 v[72:75], v17 offset:4480
    ds_read_b128 v[60:63], v17 offset:192
    ds_read_b128 v[76:79], v17 offset:4544
    ds_read_b64 v[112:113], v18
    ds_read_b64 v[114:115], v18 offset:32
    v_cmp_gt_u32 vcc, 0x180, v0
    s_and_saveexec_b64 s[32:33], vcc
    s_cbranch_execz rec_skip_pub
    s_mov_b32 s19, 0
rec_p2:
    buffer_load_dwordx4 v[32:35], v14, s[8:11], s21 offen sc1
    s_waitcnt vmcnt(0)
    v_max_u32 v27, v32, v33
    v_max3_u32 v27, v27, v34, v35
    v_cmp_eq_u32 vcc, -1, v27
    s_cbranch_vccz rec_p2d
    s_add_u32 s19, s19, 1
    s_cmp_lt_u32 s19, s20
    s_cbranch_scc1 rec_p2
    s_mov_b32 s20, 0
rec_p2d:
    ds_write_b128 v15, v[32:35]
rec_skip_pub:
    s_mov_b64 exec, s[32:33]
    s_waitcnt lgkmcnt(0)
    s_barrier
    ds_read_b128 v[32:35], v17 offset:17920
    ds_read_b128 v[80:83], v17 offset:20096
    ds_read_b128 v[36:39], v17 offset:17984
    ds_read_b128 v[84:87], v17 offset:20160
    ds_read_b128 v[40:43], v17 offset:18048
    ds_read_b128 v[88:91], v17 offset:20224
    ds_read_b128 v[44:47], v17 offset:18112
    ds_read_b128 v[92:95], v17 offset:20288
    ds_read_b64 v[116:117], v19
    s_mov_b32 s21, 1035273459
    s_mov_b32 s22, 1069066811
    s_waitcnt lgkmcnt(7)
    v_mfma_f32_16x16x32_bf16 v[96:99], v[48:51], v[32:35], 0
    v_mfma_f32_16x16x32_bf16 v[100:103], v[64:67], v[32:35], 0
    v_mfma_f32_16x16x32_bf16 v[104:107], v[80:83], v[32:35], 0
    s_waitcnt lgkmcnt(5)
    v_mfma_f32_16x16x32_bf16 v[96:99], v[52:55], v[36:39], v[96:99]
    v_mfma_f32_16x16x32_bf16 v[100:103], v[68:71], v[36:39], v[100:103]
    v_mfma_f32_16x16x32_bf16 v[104:107], v[84:87], v[36:39], v[104:107]
    s_waitcnt lgkmcnt(3)
    v_mfma_f32_16x16x32_bf16 v[96:99], v[56:59], v[40:43], v[96:99]
    v_mfma_f32_16x16x32_bf16 v[100:103], v[72:75], v[40:43], v[100:103]
    v_mfma_f32_16x16x32_bf16 v[104:107], v[88:91], v[40:43], v[104:107]
    s_waitcnt lgkmcnt(1)
    v_mfma_f32_16x16x32_bf16 v[96:99], v[60:63], v[44:47], v[96:99]
    v_mfma_f32_16x16x32_bf16 v[100:103], v[76:79], v[44:47], v[100:103]
    v_mfma_f32_16x16x32_bf16 v[104:107], v[92:95], v[44:47], v[104:107]
    v_cmp_gt_u32 vcc, 2, v4
    v_mov_b32 v27, 0xff800000
    s_nop 7
    v_cvt_pk_bf16_f32 v80, v96, v97
    v_cvt_pk_bf16_f32 v81, v98, v99
    v_cvt_pk_bf16_f32 v82, v100, v101
    v_cvt_pk_bf16_f32 v83, v102, v103
    v_cvt_pk_bf16_f32 v84, v104, v105
    v_cvt_pk_bf16_f32 v85, v106, v107
    v_lshlrev_b32 v96, 16, v80
    v_and_b32 v97, 0xffff0000, v80
    v_lshlrev_b32 v98, 16, v81
    v_and_b32 v99, 0xffff0000, v81
    v_lshlrev_b32 v100, 16, v82
    v_and_b32 v101, 0xffff0000, v82
    v_lshlrev_b32 v102, 16, v83
    v_and_b32 v103, 0xffff0000, v83
    v_lshlrev_b32 v104, 16, v84
    v_and_b32 v105, 0xffff0000, v84
    v_lshlrev_b32 v106, 16, v85
    v_and_b32 v107, 0xffff0000, v85
    v_mul_f32 v96, s21, v96
    v_mul_f32 v97, s21, v97
    v_mul_f32 v98, s21, v98
    v_mul_f32 v99, s21, v99
    v_mul_f32 v100, s21, v100
    v_mul_f32 v101, s21, v101
    v_mul_f32 v102, s21, v102
    v_mul_f32 v103, s21, v103
    v_mul_f32 v104, s21, v104
    v_mul_f32 v105, s21, v105
    v_mul_f32 v106, s21, v106
    v_mul_f32 v107, s21, v107
    v_cvt_pk_bf16_f32 v80, v96, v97
    v_cvt_pk_bf16_f32 v81, v98, v99
    v_cvt_pk_bf16_f32 v82, v100, v101
    v_cvt_pk_bf16_f32 v83, v102, v103
    v_cvt_pk_bf16_f32 v84, v104, v105
    v_cvt_pk_bf16_f32 v85, v106, v107
    v_lshlrev_b32 v96, 16, v80
    v_and_b32 v97, 0xffff0000, v80
    v_lshlrev_b32 v98, 16, v81
    v_and_b32 v99, 0xffff0000, v81
    v_lshlrev_b32 v100, 16, v82
    v_and_b32 v101, 0xffff0000, v82
    v_lshlrev_b32 v102, 16, v83
    v_and_b32 v103, 0xffff0000, v83
    v_lshlrev_b32 v104, 16, v84
    v_and_b32 v105, 0xffff0000, v84
    v_lshlrev_b32 v106, 16, v85
    v_and_b32 v107, 0xffff0000, v85
    v_cndmask_b32 v104, v27, v104, vcc
    v_cndmask_b32 v105, v27, v105, vcc
    v_cndmask_b32 v106, v27, v106, vcc
    v_cndmask_b32 v107, v27, v107, vcc
    v_max3_f32 v27, v96, v97, v98
    v_max3_f32 v29, v99, v100, v101
    v_max3_f32 v27, v27, v102, v103
    v_max3_f32 v29, v29, v104, v105
    v_max3_f32 v27, v27, v106, v107
    v_max_f32 v27, v27, v29
    v_mov_b32 v29, v27
    s_nop 1
    v_permlane16_swap_b32 v27, v29
    v_max_f32 v27, v27, v29
    v_mov_b32 v29, v27
    s_nop 1
    v_permlane32_swap_b32 v27, v29
    v_max_f32 v27, v27, v29
    v_mul_f32 v27, s22, v27
    v_fma_f32 v96, v96, s22, -v27
    v_fma_f32 v97, v97, s22, -v27
    v_fma_f32 v98, v98, s22, -v27
    v_fma_f32 v99, v99, s22, -v27
    v_fma_f32 v100, v100, s22, -v27
    v_fma_f32 v101, v101, s22, -v27
    v_fma_f32 v102, v102, s22, -v27
    v_fma_f32 v103, v103, s22, -v27
    v_fma_f32 v104, v104, s22, -v27
    v_fma_f32 v105, v105, s22, -v27
    v_fma_f32 v106, v106, s22, -v27
    v_fma_f32 v107, v107, s22, -v27
    v_exp_f32 v96, v96
    v_exp_f32 v97, v97
    v_exp_f32 v98, v98
    v_exp_f32 v99, v99
    v_exp_f32 v100, v100
    v_exp_f32 v101, v101
    v_exp_f32 v102, v102
    v_exp_f32 v103, v103
    v_exp_f32 v104, v104
    v_exp_f32 v105, v105
    v_exp_f32 v106, v106
    v_exp_f32 v107, v107
    s_nop 0
    v_add_f32 v27, v96, v97
    v_add_f32 v29, v98, v99
    v_add_f32 v27, v27, v100
    v_add_f32 v29, v29, v101
    v_add_f32 v27, v27, v102
    v_add_f32 v29, v29, v103
    v_add_f32 v27, v27, v104
    v_add_f32 v29, v29, v105
    v_add_f32 v27, v27, v106
    v_add_f32 v29, v29, v107
    v_add_f32 v27, v27, v29
    v_mov_b32 v29, v27
    s_nop 1
    v_permlane16_swap_b32 v27, v29
    v_add_f32 v27, v27, v29
    v_mov_b32 v29, v27
    s_nop 1
    v_permlane32_swap_b32 v27, v29
    v_add_f32 v27, v27, v29
    v_rcp_f32 v27, v27
    s_nop 0
    v_mul_f32 v96, v96, v27
    v_mul_f32 v97, v97, v27
    v_mul_f32 v98, v98, v27
    v_mul_f32 v99, v99, v27
    v_mul_f32 v100, v100, v27
    v_mul_f32 v101, v101, v27
    v_mul_f32 v102, v102, v27
    v_mul_f32 v103, v103, v27
    v_mul_f32 v104, v104, v27
    v_mul_f32 v105, v105, v27
    v_mul_f32 v106, v106, v27
    v_mul_f32 v107, v107, v27
    v_cvt_pk_bf16_f32 v120, v96, v97
    v_cvt_pk_bf16_f32 v121, v98, v99
    v_cvt_pk_bf16_f32 v122, v100, v101
    v_cvt_pk_bf16_f32 v123, v102, v103
    v_cvt_pk_bf16_f32 v124, v104, v105
    v_cvt_pk_bf16_f32 v125, v106, v107
    s_waitcnt lgkmcnt(0)
    s_nop 0
    v_mfma_f32_16x16x32_bf16 v[96:99], v[112:115], v[120:123], 0
    v_mfma_f32_16x16x16_bf16 v[104:107], v[116:117], v[124:125], 0
    s_nop 7
    s_nop 1
    v_add_f32 v96, v96, v104
    v_add_f32 v97, v97, v105
    v_add_f32 v98, v98, v106
    v_add_f32 v99, v99, v107
    v_cvt_pk_bf16_f32 v100, v96, v97
    v_cvt_pk_bf16_f32 v101, v98, v99
    ds_write_b64 v16, v[100:101]
    s_waitcnt lgkmcnt(0)
    s_barrier
    s_cmp_eq_u32 s18, 63
    s_cbranch_scc1 rec_done
    ds_read_b64 v[40:41], v20 offset:0
    ds_read_b64 v[42:43], v20 offset:512
    ds_read_b64 v[44:45], v20 offset:1024
    ds_read_b64 v[46:47], v20 offset:1536
    ds_read_b64 v[48:49], v20 offset:2048
    ds_read_b64 v[50:51], v20 offset:2560
    ds_read_b64 v[52:53], v20 offset:3072
    ds_read_b64 v[54:55], v20 offset:3584
    s_and_b32 s21, s18, 1
    s_lshl_b32 s21, s21, 20
    s_add_u32 s21, s21, 115343360
    s_waitcnt lgkmcnt(6)
    v_mfma_f32_16x16x32_bf16 v[56:59], v[224:227], v[40:43], 0
    v_mfma_f32_16x16x32_bf16 v[60:63], v[240:243], v[40:43], 0
    s_waitcnt lgkmcnt(4)
    v_mfma_f32_16x16x32_bf16 v[56:59], v[228:231], v[44:47], v[56:59]
    v_mfma_f32_16x16x32_bf16 v[60:63], v[244:247], v[44:47], v[60:63]
    s_waitcnt lgkmcnt(2)
    v_mfma_f32_16x16x32_bf16 v[56:59], v[232:235], v[48:51], v[56:59]
    v_mfma_f32_16x16x32_bf16 v[60:63], v[248:251], v[48:51], v[60:63]
    s_waitcnt lgkmcnt(0)
    v_mfma_f32_16x16x32_bf16 v[56:59], v[236:239], v[52:55], v[56:59]
    v_mfma_f32_16x16x32_bf16 v[60:63], v[252:255], v[52:55], v[60:63]
    s_nop 7
    s_nop 1
    v_cmp_eq_u32 vcc, -1, v56
    s_nop 1
    v_cndmask_b32 v56, v56, v25, vcc
    v_cmp_eq_u32 vcc, -1, v57
    s_nop 1
    v_cndmask_b32 v57, v57, v25, vcc
    v_cmp_eq_u32 vcc, -1, v58
    s_nop 1
    v_cndmask_b32 v58, v58, v25, vcc
    v_cmp_eq_u32 vcc, -1, v59
    s_nop 1
    v_cndmask_b32 v59, v59, v25, vcc
    v_cmp_eq_u32 vcc, -1, v60
    s_nop 1
    v_cndmask_b32 v60, v60, v25, vcc
    v_cmp_eq_u32 vcc, -1, v61
    s_nop 1
    v_cndmask_b32 v61, v61, v25, vcc
    v_cmp_eq_u32 vcc, -1, v62
    s_nop 1
    v_cndmask_b32 v62, v62, v25, vcc
    v_cmp_eq_u32 vcc, -1, v63
    s_nop 1
    v_cndmask_b32 v63, v63, v25, vcc
    v_cmp_gt_u32 vcc, 8, v3
    s_and_saveexec_b64 s[32:33], vcc
    buffer_store_dwordx4 v[56:59], v22, s[8:11], s21 offen sc1
    buffer_store_dwordx4 v[60:63], v22, s[8:11], s21 offen offset:512 sc1
    s_mov_b64 exec, s[32:33]
    v_readfirstlane_b32 s22, v2
    s_cmp_lg_u32 s22, 0
    s_cbranch_scc1 rec_next
    s_mov_b32 s19, 0
rec_p3:
    s_mov_b32 s22, s21
    buffer_load_dwordx4 v[64:67], v23, s[8:11], s22 offen sc1
    s_add_u32 s22, s22, 32768
    buffer_load_dwordx4 v[68:71], v23, s[8:11], s22 offen sc1
    s_add_u32 s22, s22, 32768
    buffer_load_dwordx4 v[72:75], v23, s[8:11], s22 offen sc1
    s_add_u32 s22, s22, 32768
    buffer_load_dwordx4 v[76:79], v23, s[8:11], s22 offen sc1
    s_add_u32 s22, s22, 32768
    buffer_load_dwordx4 v[80:83], v23, s[8:11], s22 offen sc1
    s_add_u32 s22, s22, 32768
    buffer_load_dwordx4 v[84:87], v23, s[8:11], s22 offen sc1
    s_add_u32 s22, s22, 32768
    buffer_load_dwordx4 v[88:91], v23, s[8:11], s22 offen sc1
    s_add_u32 s22, s22, 32768
    buffer_load_dwordx4 v[92:95], v23, s[8:11], s22 offen sc1
    s_waitcnt vmcnt(0)
    v_max_u32 v27, v64, v65
    v_max3_u32 v27, v27, v66, v67
    v_max3_u32 v27, v27, v68, v69
    v_max3_u32 v27, v27, v70, v71
    v_max3_u32 v27, v27, v72, v73
    v_max3_u32 v27, v27, v74, v75
    v_max3_u32 v27, v27, v76, v77
    v_max3_u32 v27, v27, v78, v79
    v_max3_u32 v27, v27, v80, v81
    v_max3_u32 v27, v27, v82, v83
    v_max3_u32 v27, v27, v84, v85
    v_max3_u32 v27, v27, v86, v87
    v_max3_u32 v27, v27, v88, v89
    v_max3_u32 v27, v27, v90, v91
    v_max3_u32 v27, v27, v92, v93
    v_max3_u32 v27, v27, v94, v95
    v_cmp_eq_u32 vcc, -1, v27
    s_cbranch_vccz rec_p3d
    s_add_u32 s19, s19, 1
    s_cmp_lt_u32 s19, s20
    s_cbranch_scc1 rec_p3
    s_mov_b32 s20, 0
rec_p3d:
    v_add_f32 v64, v64, v68
    v_add_f32 v65, v65, v69
    v_add_f32 v66, v66, v70
    v_add_f32 v67, v67, v71
    v_add_f32 v72, v72, v76
    v_add_f32 v73, v73, v77
    v_add_f32 v74, v74, v78
    v_add_f32 v75, v75, v79
    v_add_f32 v80, v80, v84
    v_add_f32 v81, v81, v85
    v_add_f32 v82, v82, v86
    v_add_f32 v83, v83, v87
    v_add_f32 v88, v88, v92
    v_add_f32 v89, v89, v93
    v_add_f32 v90, v90, v94
    v_add_f32 v91, v91, v95
    v_add_f32 v64, v64, v72
    v_add_f32 v65, v65, v73
    v_add_f32 v66, v66, v74
    v_add_f32 v67, v67, v75
    v_add_f32 v80, v80, v88
    v_add_f32 v81, v81, v89
    v_add_f32 v82, v82, v90
    v_add_f32 v83, v83, v91
    v_add_f32 v64, v64, v80
    v_add_f32 v65, v65, v81
    v_add_f32 v66, v66, v82
    v_add_f32 v67, v67, v83
    v_mov_b32 v68, v64
    s_nop 1
    v_permlane16_swap_b32 v64, v68
    v_add_f32 v64, v64, v68
    v_mov_b32 v68, v64
    s_nop 1
    v_permlane32_swap_b32 v64, v68
    v_add_f32 v64, v64, v68
    v_mov_b32 v69, v65
    s_nop 1
    v_permlane16_swap_b32 v65, v69
    v_add_f32 v65, v65, v69
    v_mov_b32 v69, v65
    s_nop 1
    v_permlane32_swap_b32 v65, v69
    v_add_f32 v65, v65, v69
    v_mov_b32 v70, v66
    s_nop 1
    v_permlane16_swap_b32 v66, v70
    v_add_f32 v66, v66, v70
    v_mov_b32 v70, v66
    s_nop 1
    v_permlane32_swap_b32 v66, v70
    v_add_f32 v66, v66, v70
    v_mov_b32 v71, v67
    s_nop 1
    v_permlane16_swap_b32 v67, v71
    v_add_f32 v67, v67, v71
    v_mov_b32 v71, v67
    s_nop 1
    v_permlane32_swap_b32 v67, v71
    v_add_f32 v67, v67, v71
    v_cvt_pk_bf16_f32 v40, v64, v65
    v_cvt_pk_bf16_f32 v41, v66, v67
    v_cmp_eq_u32 vcc, -1, v40
    s_nop 1
    v_cndmask_b32 v40, v40, v25, vcc
    v_cmp_eq_u32 vcc, -1, v41
    s_nop 1
    v_cndmask_b32 v41, v41, v25, vcc
    s_add_u32 s22, s18, 1
    s_lshl_b32 s22, s22, 14
    s_add_u32 s22, s22, 100663296
    v_cmp_gt_u32 vcc, 16, v1
    s_and_saveexec_b64 s[32:33], vcc
    buffer_store_dwordx2 v[40:41], v24, s[8:11], s22 offen sc1
    s_mov_b64 exec, s[32:33]
    v_mov_b32 v64, -1
    v_mov_b32 v65, -1
    v_mov_b32 v66, -1
    v_mov_b32 v67, -1
    s_mov_b32 s22, s21
    buffer_store_dwordx4 v[64:67], v23, s[8:11], s22 offen sc1
    s_add_u32 s22, s22, 32768
    buffer_store_dwordx4 v[64:67], v23, s[8:11], s22 offen sc1
    s_add_u32 s22, s22, 32768
    buffer_store_dwordx4 v[64:67], v23, s[8:11], s22 offen sc1
    s_add_u32 s22, s22, 32768
    buffer_store_dwordx4 v[64:67], v23, s[8:11], s22 offen sc1
    s_add_u32 s22, s22, 32768
    buffer_store_dwordx4 v[64:67], v23, s[8:11], s22 offen sc1
    s_add_u32 s22, s22, 32768
    buffer_store_dwordx4 v[64:67], v23, s[8:11], s22 offen sc1
    s_add_u32 s22, s22, 32768
    buffer_store_dwordx4 v[64:67], v23, s[8:11], s22 offen sc1
    s_add_u32 s22, s22, 32768
    buffer_store_dwordx4 v[64:67], v23, s[8:11], s22 offen sc1
rec_next:
    s_add_u32 s18, s18, 1
    s_branch rec_step
rec_worker:
    v_lshrrev_b32 v1, 8, v0
    s_nop 1
    v_readfirstlane_b32 s57, v1
    v_and_b32 v0, 0xff, v0
    s_sub_u32 s60, s2, 128
    s_lshl_b32 s60, s60, 1
    s_add_u32 s60, s60, s57
    s_mul_i32 s57, s57, 77824
    s_load_dwordx4 s[16:19], s[0:1], 16
    s_load_dwordx2 s[20:21], s[0:1], 32
    s_load_dwordx4 s[24:27], s[0:1], 64
    s_load_dwordx2 s[28:29], s[0:1], 112
    s_load_dwordx4 s[64:67], s[0:1], 80
    s_load_dwordx2 s[68:69], s[0:1], 112
    s_mov_b32 s61, s60
    s_waitcnt lgkmcnt(0)
    s_and_b32 s59, s60, 1
    s_lshr_b32 s61, s60, 1
wk_kv:
    s_cmp_ge_u32 s61, 1024
    s_cbranch_scc1 wk_kv_end
    s_lshr_b32 s3, s61, 6
    s_and_b32 s4, s61, 63
    s_add_u32 s4, s4, 32
    s_lshr_b32 s5, s4, 5
    s_mov_b32 s40, 18432
    s_cmp_eq_u32 s5, 0
    s_cselect_b32 s6, s16, s18
    s_cselect_b32 s7, s17, s19
    s_cmp_eq_u32 s5, 2
    s_cselect_b32 s6, s20, s6
    s_cselect_b32 s7, s21, s7
    s_cmp_eq_u32 s5, 3
    s_cselect_b32 s6, s24, s6
    s_cselect_b32 s7, s25, s7
    s_mov_b32 s30, 8192
    s_cselect_b32 s30, 7168, s30
    s_mov_b32 s31, 8388608
    s_cselect_b32 s31, 7340032, s31
    s_cselect_b32 s32, 4194304, 0
    s_mov_b32 s12, s6
    s_mov_b32 s13, s7
    s_mov_b32 s14, s31
    s_mov_b32 s15, 0x00020000
    s_mov_b32 s8, s28
    s_mov_b32 s9, s29
    s_mov_b32 s10, 268435456
    s_mov_b32 s11, 0x00020000
    s_and_b32 s33, s4, 31
    v_and_b32 v6, 63, v0
    v_lshrrev_b32 v7, 6, v0
    v_lshrrev_b32 v1, 3, v0
    v_mul_u32_u24 v2, 144, v1
    v_and_b32 v1, 7, v0
    v_lshlrev_b32 v1, 4, v1
    v_add_u32 v2, v2, v1
    v_lshrrev_b32 v1, 4, v0
    v_mul_u32_u24 v3, 320, v1
    v_and_b32 v1, 15, v0
    v_lshlrev_b32 v1, 4, v1
    v_add3_u32 v3, v3, v1, s40
    v_lshrrev_b32 v1, 1, v7
    v_lshlrev_b32 v1, 6, v1
    v_and_b32 v8, 31, v6
    v_add_u32 v1, v1, v8
    v_mul_u32_u24 v4, 144, v1
    v_lshrrev_b32 v1, 5, v6
    v_lshlrev_b32 v1, 4, v1
    v_add_u32 v4, v4, v1
    v_lshrrev_b32 v1, 5, v6
    v_lshlrev_b32 v1, 3, v1
    v_and_b32 v8, 15, v6
    v_lshrrev_b32 v8, 2, v8
    v_add_u32 v1, v1, v8
    v_mul_u32_u24 v5, 320, v1
    v_and_b32 v1, 1, v7
    v_lshlrev_b32 v1, 7, v1
    v_bfe_u32 v8, v6, 4, 1
    v_lshlrev_b32 v8, 5, v8
    v_add_u32 v1, v1, v8
    v_and_b32 v8, 3, v6
    v_lshlrev_b32 v8, 3, v8
    v_add3_u32 v5, v5, v1, v8
    v_add_u32 v5, s40, v5
    v_add_u32 v2, s57, v2
    v_add_u32 v3, s57, v3
    v_add_u32 v4, s57, v4
    v_add_u32 v5, s57, v5
    v_lshrrev_b32 v1, 3, v0
    s_lshl_b32 s34, s3, 7
    v_add_u32 v1, s34, v1
    v_lshlrev_b32 v10, 11, v1
    v_and_b32 v1, 7, v0
    v_lshlrev_b32 v1, 4, v1
    v_add3_u32 v10, v10, v1, s32
    v_lshrrev_b32 v1, 4, v0
    v_mul_lo_u32 v11, v1, s30
    v_and_b32 v1, 15, v0
    v_lshlrev_b32 v1, 4, v1
    s_lshl_b32 s34, s33, 8
    v_add3_u32 v11, v11, v1, s34
    s_mov_b32 s48, 0
    s_mul_i32 s52, s30, 0
    s_mov_b32 s49, 65536
    s_mul_i32 s53, s30, 16
    s_mov_b32 s50, 131072
    s_mul_i32 s54, s30, 32
    s_mov_b32 s51, 196608
    s_mul_i32 s55, s30, 48
    s_lshl_b32 s37, s59, 10
    s_lshl_b32 s38, s30, 9
    s_mul_i32 s38, s38, s59
    s_add_u32 s48, s48, s37
    s_add_u32 s52, s52, s38
    s_add_u32 s49, s49, s37
    s_add_u32 s53, s53, s38
    s_add_u32 s50, s50, s37
    s_add_u32 s54, s54, s38
    s_add_u32 s51, s51, s37
    s_add_u32 s55, s55, s38
    s_lshl_b32 s35, s30, 6
    v_mov_b32 v80, 0
    v_mov_b32 v81, 0
    v_mov_b32 v82, 0
    v_mov_b32 v83, 0
    v_mov_b32 v84, 0
    v_mov_b32 v85, 0
    v_mov_b32 v86, 0
    v_mov_b32 v87, 0
    v_mov_b32 v88, 0
    v_mov_b32 v89, 0
    v_mov_b32 v90, 0
    v_mov_b32 v91, 0
    v_mov_b32 v92, 0
    v_mov_b32 v93, 0
    v_mov_b32 v94, 0
    v_mov_b32 v95, 0
    v_mov_b32 v96, 0
    v_mov_b32 v97, 0
    v_mov_b32 v98, 0
    v_mov_b32 v99, 0
    v_mov_b32 v100, 0
    v_mov_b32 v101, 0
    v_mov_b32 v102, 0
    v_mov_b32 v103, 0
    v_mov_b32 v104, 0
    v_mov_b32 v105, 0
    v_mov_b32 v106, 0
    v_mov_b32 v107, 0
    v_mov_b32 v108, 0
    v_mov_b32 v109, 0
    v_mov_b32 v110, 0
    v_mov_b32 v111, 0
    v_mov_b32 v112, 0
    v_mov_b32 v113, 0
    v_mov_b32 v114, 0
    v_mov_b32 v115, 0
    v_mov_b32 v116, 0
    v_mov_b32 v117, 0
    v_mov_b32 v118, 0
    v_mov_b32 v119, 0
    v_mov_b32 v120, 0
    v_mov_b32 v121, 0
    v_mov_b32 v122, 0
    v_mov_b32 v123, 0
    v_mov_b32 v124, 0
    v_mov_b32 v125, 0
    v_mov_b32 v126, 0
    v_mov_b32 v127, 0
    v_mov_b32 v128, 0
    v_mov_b32 v129, 0
    v_mov_b32 v130, 0
    v_mov_b32 v131, 0
    v_mov_b32 v132, 0
    v_mov_b32 v133, 0
    v_mov_b32 v134, 0
    v_mov_b32 v135, 0
    v_mov_b32 v136, 0
    v_mov_b32 v137, 0
    v_mov_b32 v138, 0
    v_mov_b32 v139, 0
    v_mov_b32 v140, 0
    v_mov_b32 v141, 0
    v_mov_b32 v142, 0
    v_mov_b32 v143, 0
    s_cmp_eq_u32 s5, 2
    s_cbranch_scc1 wkv_vpath
    buffer_load_dwordx4 v[16:19], v10, s[8:11], s48 offen
    buffer_load_dwordx4 v[20:23], v10, s[8:11], s49 offen
    buffer_load_dwordx4 v[24:27], v10, s[8:11], s50 offen
    buffer_load_dwordx4 v[28:31], v10, s[8:11], s51 offen
    buffer_load_dwordx4 v[32:35], v11, s[12:15], s52 offen
    buffer_load_dwordx4 v[36:39], v11, s[12:15], s53 offen
    buffer_load_dwordx4 v[40:43], v11, s[12:15], s54 offen
    buffer_load_dwordx4 v[44:47], v11, s[12:15], s55 offen
    s_add_u32 s48, s48, 128
    s_add_u32 s52, s52, s35
    s_add_u32 s49, s49, 128
    s_add_u32 s53, s53, s35
    s_add_u32 s50, s50, 128
    s_add_u32 s54, s54, s35
    s_add_u32 s51, s51, 128
    s_add_u32 s55, s55, s35
    buffer_load_dwordx4 v[176:179], v10, s[8:11], s48 offen
    buffer_load_dwordx4 v[180:183], v10, s[8:11], s49 offen
    buffer_load_dwordx4 v[184:187], v10, s[8:11], s50 offen
    buffer_load_dwordx4 v[188:191], v10, s[8:11], s51 offen
    buffer_load_dwordx4 v[192:195], v11, s[12:15], s52 offen
    buffer_load_dwordx4 v[196:199], v11, s[12:15], s53 offen
    buffer_load_dwordx4 v[200:203], v11, s[12:15], s54 offen
    buffer_load_dwordx4 v[204:207], v11, s[12:15], s55 offen
    s_add_u32 s48, s48, 128
    s_add_u32 s52, s52, s35
    s_add_u32 s49, s49, 128
    s_add_u32 s53, s53, s35
    s_add_u32 s50, s50, 128
    s_add_u32 s54, s54, s35
    s_add_u32 s51, s51, 128
    s_add_u32 s55, s55, s35
    s_waitcnt vmcnt(8)
    ds_write_b128 v2, v[16:19] offset:0
    ds_write_b128 v2, v[20:23] offset:4608
    ds_write_b128 v2, v[24:27] offset:9216
    ds_write_b128 v2, v[28:31] offset:13824
    ds_write_b128 v3, v[32:35] offset:0
    ds_write_b128 v3, v[36:39] offset:5120
    ds_write_b128 v3, v[40:43] offset:10240
    ds_write_b128 v3, v[44:47] offset:15360
    s_waitcnt lgkmcnt(0)
    s_barrier
    s_mov_b32 s36, 4
gloop_1:
    buffer_load_dwordx4 v[16:19], v10, s[8:11], s48 offen
    buffer_load_dwordx4 v[20:23], v10, s[8:11], s49 offen
    buffer_load_dwordx4 v[24:27], v10, s[8:11], s50 offen
    buffer_load_dwordx4 v[28:31], v10, s[8:11], s51 offen
    buffer_load_dwordx4 v[32:35], v11, s[12:15], s52 offen
    buffer_load_dwordx4 v[36:39], v11, s[12:15], s53 offen
    buffer_load_dwordx4 v[40:43], v11, s[12:15], s54 offen
    buffer_load_dwordx4 v[44:47], v11, s[12:15], s55 offen
    s_add_u32 s48, s48, 128
    s_add_u32 s52, s52, s35
    s_add_u32 s49, s49, 128
    s_add_u32 s53, s53, s35
    s_add_u32 s50, s50, 128
    s_add_u32 s54, s54, s35
    s_add_u32 s51, s51, 128
    s_add_u32 s55, s55, s35
    ds_read_b128 v[48:51], v4 offset:0
    ds_read_b128 v[52:55], v4 offset:4608
    ds_read_b64_tr_b16 v[56:57], v5 offset:0
    ds_read_b64_tr_b16 v[58:59], v5 offset:1280
    ds_read_b64_tr_b16 v[60:61], v5 offset:64
    ds_read_b64_tr_b16 v[62:63], v5 offset:1344
    ds_read_b128 v[64:67], v4 offset:32
    ds_read_b128 v[68:71], v4 offset:4640
    ds_read_b64_tr_b16 v[72:73], v5 offset:5120
    ds_read_b64_tr_b16 v[74:75], v5 offset:6400
    ds_read_b64_tr_b16 v[76:77], v5 offset:5184
    ds_read_b64_tr_b16 v[78:79], v5 offset:6464
    s_waitcnt lgkmcnt(6)
    v_mfma_f32_32x32x16_bf16 v[80:95], v[56:59], v[48:51], v[80:95]
    v_mfma_f32_32x32x16_bf16 v[96:111], v[60:63], v[48:51], v[96:111]
    v_mfma_f32_32x32x16_bf16 v[112:127], v[56:59], v[52:55], v[112:127]
    v_mfma_f32_32x32x16_bf16 v[128:143], v[60:63], v[52:55], v[128:143]
    ds_read_b128 v[48:51], v4 offset:64
    ds_read_b128 v[52:55], v4 offset:4672
    ds_read_b64_tr_b16 v[56:57], v5 offset:10240
    ds_read_b64_tr_b16 v[58:59], v5 offset:11520
    ds_read_b64_tr_b16 v[60:61], v5 offset:10304
    ds_read_b64_tr_b16 v[62:63], v5 offset:11584
    s_waitcnt lgkmcnt(6)
    v_mfma_f32_32x32x16_bf16 v[80:95], v[72:75], v[64:67], v[80:95]
    v_mfma_f32_32x32x16_bf16 v[96:111], v[76:79], v[64:67], v[96:111]
    v_mfma_f32_32x32x16_bf16 v[112:127], v[72:75], v[68:71], v[112:127]
    v_mfma_f32_32x32x16_bf16 v[128:143], v[76:79], v[68:71], v[128:143]
    ds_read_b128 v[64:67], v4 offset:96
    ds_read_b128 v[68:71], v4 offset:4704
    ds_read_b64_tr_b16 v[72:73], v5 offset:15360
    ds_read_b64_tr_b16 v[74:75], v5 offset:16640
    ds_read_b64_tr_b16 v[76:77], v5 offset:15424
    ds_read_b64_tr_b16 v[78:79], v5 offset:16704
    s_waitcnt lgkmcnt(6)
    v_mfma_f32_32x32x16_bf16 v[80:95], v[56:59], v[48:51], v[80:95]
    v_mfma_f32_32x32x16_bf16 v[96:111], v[60:63], v[48:51], v[96:111]
    v_mfma_f32_32x32x16_bf16 v[112:127], v[56:59], v[52:55], v[112:127]
    v_mfma_f32_32x32x16_bf16 v[128:143], v[60:63], v[52:55], v[128:143]
    s_waitcnt lgkmcnt(0)
    v_mfma_f32_32x32x16_bf16 v[80:95], v[72:75], v[64:67], v[80:95]
    v_mfma_f32_32x32x16_bf16 v[96:111], v[76:79], v[64:67], v[96:111]
    v_mfma_f32_32x32x16_bf16 v[112:127], v[72:75], v[68:71], v[112:127]
    v_mfma_f32_32x32x16_bf16 v[128:143], v[76:79], v[68:71], v[128:143]
    s_waitcnt vmcnt(8)
    ds_write_b128 v2, v[176:179] offset:38912
    ds_write_b128 v2, v[180:183] offset:43520
    ds_write_b128 v2, v[184:187] offset:48128
    ds_write_b128 v2, v[188:191] offset:52736
    ds_write_b128 v3, v[192:195] offset:38912
    ds_write_b128 v3, v[196:199] offset:44032
    ds_write_b128 v3, v[200:203] offset:49152
    ds_write_b128 v3, v[204:207] offset:54272
    s_waitcnt lgkmcnt(0)
    s_barrier
    buffer_load_dwordx4 v[176:179], v10, s[8:11], s48 offen
    buffer_load_dwordx4 v[180:183], v10, s[8:11], s49 offen
    buffer_load_dwordx4 v[184:187], v10, s[8:11], s50 offen
    buffer_load_dwordx4 v[188:191], v10, s[8:11], s51 offen
    buffer_load_dwordx4 v[192:195], v11, s[12:15], s52 offen
    buffer_load_dwordx4 v[196:199], v11, s[12:15], s53 offen
    buffer_load_dwordx4 v[200:203], v11, s[12:15], s54 offen
    buffer_load_dwordx4 v[204:207], v11, s[12:15], s55 offen
    s_add_u32 s48, s48, 128
    s_add_u32 s52, s52, s35
    s_add_u32 s49, s49, 128
    s_add_u32 s53, s53, s35
    s_add_u32 s50, s50, 128
    s_add_u32 s54, s54, s35
    s_add_u32 s51, s51, 128
    s_add_u32 s55, s55, s35
    ds_read_b128 v[48:51], v4 offset:38912
    ds_read_b128 v[52:55], v4 offset:43520
    ds_read_b64_tr_b16 v[56:57], v5 offset:38912
    ds_read_b64_tr_b16 v[58:59], v5 offset:40192
    ds_read_b64_tr_b16 v[60:61], v5 offset:38976
    ds_read_b64_tr_b16 v[62:63], v5 offset:40256
    ds_read_b128 v[64:67], v4 offset:38944
    ds_read_b128 v[68:71], v4 offset:43552
    ds_read_b64_tr_b16 v[72:73], v5 offset:44032
    ds_read_b64_tr_b16 v[74:75], v5 offset:45312
    ds_read_b64_tr_b16 v[76:77], v5 offset:44096
    ds_read_b64_tr_b16 v[78:79], v5 offset:45376
    s_waitcnt lgkmcnt(6)
    v_mfma_f32_32x32x16_bf16 v[80:95], v[56:59], v[48:51], v[80:95]
    v_mfma_f32_32x32x16_bf16 v[96:111], v[60:63], v[48:51], v[96:111]
    v_mfma_f32_32x32x16_bf16 v[112:127], v[56:59], v[52:55], v[112:127]
    v_mfma_f32_32x32x16_bf16 v[128:143], v[60:63], v[52:55], v[128:143]
    ds_read_b128 v[48:51], v4 offset:38976
    ds_read_b128 v[52:55], v4 offset:43584
    ds_read_b64_tr_b16 v[56:57], v5 offset:49152
    ds_read_b64_tr_b16 v[58:59], v5 offset:50432
    ds_read_b64_tr_b16 v[60:61], v5 offset:49216
    ds_read_b64_tr_b16 v[62:63], v5 offset:50496
    s_waitcnt lgkmcnt(6)
    v_mfma_f32_32x32x16_bf16 v[80:95], v[72:75], v[64:67], v[80:95]
    v_mfma_f32_32x32x16_bf16 v[96:111], v[76:79], v[64:67], v[96:111]
    v_mfma_f32_32x32x16_bf16 v[112:127], v[72:75], v[68:71], v[112:127]
    v_mfma_f32_32x32x16_bf16 v[128:143], v[76:79], v[68:71], v[128:143]
    ds_read_b128 v[64:67], v4 offset:39008
    ds_read_b128 v[68:71], v4 offset:43616
    ds_read_b64_tr_b16 v[72:73], v5 offset:54272
    ds_read_b64_tr_b16 v[74:75], v5 offset:55552
    ds_read_b64_tr_b16 v[76:77], v5 offset:54336
    ds_read_b64_tr_b16 v[78:79], v5 offset:55616
    s_waitcnt lgkmcnt(6)
    v_mfma_f32_32x32x16_bf16 v[80:95], v[56:59], v[48:51], v[80:95]
    v_mfma_f32_32x32x16_bf16 v[96:111], v[60:63], v[48:51], v[96:111]
    v_mfma_f32_32x32x16_bf16 v[112:127], v[56:59], v[52:55], v[112:127]
    v_mfma_f32_32x32x16_bf16 v[128:143], v[60:63], v[52:55], v[128:143]
    s_waitcnt lgkmcnt(0)
    v_mfma_f32_32x32x16_bf16 v[80:95], v[72:75], v[64:67], v[80:95]
    v_mfma_f32_32x32x16_bf16 v[96:111], v[76:79], v[64:67], v[96:111]
    v_mfma_f32_32x32x16_bf16 v[112:127], v[72:75], v[68:71], v[112:127]
    v_mfma_f32_32x32x16_bf16 v[128:143], v[76:79], v[68:71], v[128:143]
    s_waitcnt vmcnt(8)
    ds_write_b128 v2, v[16:19] offset:0
    ds_write_b128 v2, v[20:23] offset:4608
    ds_write_b128 v2, v[24:27] offset:9216
    ds_write_b128 v2, v[28:31] offset:13824
    ds_write_b128 v3, v[32:35] offset:0
    ds_write_b128 v3, v[36:39] offset:5120
    ds_write_b128 v3, v[40:43] offset:10240
    ds_write_b128 v3, v[44:47] offset:15360
    s_waitcnt lgkmcnt(0)
    s_barrier
    s_sub_u32 s36, s36, 1
    s_cmp_lg_u32 s36, 0
    s_cbranch_scc1 gloop_1
    s_waitcnt vmcnt(0)
    s_nop 7
    s_nop 7
    v_lshlrev_b32 v1, 4, v0
    s_cmp_eq_u32 s59, 0
    s_cbranch_scc1 wkv_kc0
    ds_write_b128 v1, v[80:83] offset:0
    ds_write_b128 v1, v[84:87] offset:4096
    ds_write_b128 v1, v[88:91] offset:8192
    ds_write_b128 v1, v[92:95] offset:12288
    ds_write_b128 v1, v[96:99] offset:16384
    ds_write_b128 v1, v[100:103] offset:20480
    ds_write_b128 v1, v[104:107] offset:24576
    ds_write_b128 v1, v[108:111] offset:28672
    ds_write_b128 v1, v[112:115] offset:32768
    ds_write_b128 v1, v[116:119] offset:36864
    ds_write_b128 v1, v[120:123] offset:40960
    ds_write_b128 v1, v[124:127] offset:45056
    ds_write_b128 v1, v[128:131] offset:49152
    ds_write_b128 v1, v[132:135] offset:53248
    ds_write_b128 v1, v[136:139] offset:57344
    ds_write_b128 v1, v[140:143] offset:61440
wkv_kc0:
    s_waitcnt lgkmcnt(0)
    s_barrier
    s_cmp_lg_u32 s59, 0
    s_cbranch_scc1 wkv_done
    ds_read_b128 v[144:147], v1 offset:0
    ds_read_b128 v[148:151], v1 offset:4096
    ds_read_b128 v[152:155], v1 offset:8192
    ds_read_b128 v[156:159], v1 offset:12288
    ds_read_b128 v[160:163], v1 offset:16384
    ds_read_b128 v[164:167], v1 offset:20480
    ds_read_b128 v[168:171], v1 offset:24576
    ds_read_b128 v[172:175], v1 offset:28672
    s_waitcnt lgkmcnt(0)
    v_add_f32 v80, v80, v144
    v_add_f32 v81, v81, v145
    v_add_f32 v82, v82, v146
    v_add_f32 v83, v83, v147
    v_add_f32 v84, v84, v148
    v_add_f32 v85, v85, v149
    v_add_f32 v86, v86, v150
    v_add_f32 v87, v87, v151
    v_add_f32 v88, v88, v152
    v_add_f32 v89, v89, v153
    v_add_f32 v90, v90, v154
    v_add_f32 v91, v91, v155
    v_add_f32 v92, v92, v156
    v_add_f32 v93, v93, v157
    v_add_f32 v94, v94, v158
    v_add_f32 v95, v95, v159
    v_add_f32 v96, v96, v160
    v_add_f32 v97, v97, v161
    v_add_f32 v98, v98, v162
    v_add_f32 v99, v99, v163
    v_add_f32 v100, v100, v164
    v_add_f32 v101, v101, v165
    v_add_f32 v102, v102, v166
    v_add_f32 v103, v103, v167
    v_add_f32 v104, v104, v168
    v_add_f32 v105, v105, v169
    v_add_f32 v106, v106, v170
    v_add_f32 v107, v107, v171
    v_add_f32 v108, v108, v172
    v_add_f32 v109, v109, v173
    v_add_f32 v110, v110, v174
    v_add_f32 v111, v111, v175
    ds_read_b128 v[144:147], v1 offset:32768
    ds_read_b128 v[148:151], v1 offset:36864
    ds_read_b128 v[152:155], v1 offset:40960
    ds_read_b128 v[156:159], v1 offset:45056
    ds_read_b128 v[160:163], v1 offset:49152
    ds_read_b128 v[164:167], v1 offset:53248
    ds_read_b128 v[168:171], v1 offset:57344
    ds_read_b128 v[172:175], v1 offset:61440
    s_waitcnt lgkmcnt(0)
    v_add_f32 v112, v112, v144
    v_add_f32 v113, v113, v145
    v_add_f32 v114, v114, v146
    v_add_f32 v115, v115, v147
    v_add_f32 v116, v116, v148
    v_add_f32 v117, v117, v149
    v_add_f32 v118, v118, v150
    v_add_f32 v119, v119, v151
    v_add_f32 v120, v120, v152
    v_add_f32 v121, v121, v153
    v_add_f32 v122, v122, v154
    v_add_f32 v123, v123, v155
    v_add_f32 v124, v124, v156
    v_add_f32 v125, v125, v157
    v_add_f32 v126, v126, v158
    v_add_f32 v127, v127, v159
    v_add_f32 v128, v128, v160
    v_add_f32 v129, v129, v161
    v_add_f32 v130, v130, v162
    v_add_f32 v131, v131, v163
    v_add_f32 v132, v132, v164
    v_add_f32 v133, v133, v165
    v_add_f32 v134, v134, v166
    v_add_f32 v135, v135, v167
    v_add_f32 v136, v136, v168
    v_add_f32 v137, v137, v169
    v_add_f32 v138, v138, v170
    v_add_f32 v139, v139, v171
    v_add_f32 v140, v140, v172
    v_add_f32 v141, v141, v173
    v_add_f32 v142, v142, v174
    v_add_f32 v143, v143, v175
    s_cmp_eq_u32 s5, 0
    s_mov_b32 s36, 25165824
    s_cselect_b32 s36, 8388608, s36
    v_lshrrev_b32 v1, 1, v7
    v_lshlrev_b32 v1, 6, v1
    v_and_b32 v8, 31, v6
    s_lshl_b32 s34, s3, 7
    v_add3_u32 v1, v1, v8, s34
    v_lshlrev_b32 v12, 13, v1
    v_and_b32 v1, 1, v7
    v_lshlrev_b32 v1, 7, v1
    v_lshrrev_b32 v8, 5, v6
    v_lshlrev_b32 v8, 3, v8
    s_lshl_b32 s34, s33, 8
    v_add3_u32 v1, v1, v8, s34
    v_add_u32 v12, v12, v1
    v_add_u32 v13, 0x40000, v12
    v_cvt_pk_bf16_f32 v16, v80, v81
    v_cvt_pk_bf16_f32 v17, v82, v83
    buffer_store_dwordx2 v[16:17], v12, s[8:11], s36 offen offset:0 sc1
    v_cvt_pk_bf16_f32 v18, v84, v85
    v_cvt_pk_bf16_f32 v19, v86, v87
    buffer_store_dwordx2 v[18:19], v12, s[8:11], s36 offen offset:16 sc1
    v_cvt_pk_bf16_f32 v20, v88, v89
    v_cvt_pk_bf16_f32 v21, v90, v91
    buffer_store_dwordx2 v[20:21], v12, s[8:11], s36 offen offset:32 sc1
    v_cvt_pk_bf16_f32 v22, v92, v93
    v_cvt_pk_bf16_f32 v23, v94, v95
    buffer_store_dwordx2 v[22:23], v12, s[8:11], s36 offen offset:48 sc1
    v_cvt_pk_bf16_f32 v24, v96, v97
    v_cvt_pk_bf16_f32 v25, v98, v99
    buffer_store_dwordx2 v[24:25], v12, s[8:11], s36 offen offset:64 sc1
    v_cvt_pk_bf16_f32 v26, v100, v101
    v_cvt_pk_bf16_f32 v27, v102, v103
    buffer_store_dwordx2 v[26:27], v12, s[8:11], s36 offen offset:80 sc1
    v_cvt_pk_bf16_f32 v28, v104, v105
    v_cvt_pk_bf16_f32 v29, v106, v107
    buffer_store_dwordx2 v[28:29], v12, s[8:11], s36 offen offset:96 sc1
    v_cvt_pk_bf16_f32 v30, v108, v109
    v_cvt_pk_bf16_f32 v31, v110, v111
    buffer_store_dwordx2 v[30:31], v12, s[8:11], s36 offen offset:112 sc1
    v_cvt_pk_bf16_f32 v16, v112, v113
    v_cvt_pk_bf16_f32 v17, v114, v115
    buffer_store_dwordx2 v[16:17], v13, s[8:11], s36 offen offset:0 sc1
    v_cvt_pk_bf16_f32 v18, v116, v117
    v_cvt_pk_bf16_f32 v19, v118, v119
    buffer_store_dwordx2 v[18:19], v13, s[8:11], s36 offen offset:16 sc1
    v_cvt_pk_bf16_f32 v20, v120, v121
    v_cvt_pk_bf16_f32 v21, v122, v123
    buffer_store_dwordx2 v[20:21], v13, s[8:11], s36 offen offset:32 sc1
    v_cvt_pk_bf16_f32 v22, v124, v125
    v_cvt_pk_bf16_f32 v23, v126, v127
    buffer_store_dwordx2 v[22:23], v13, s[8:11], s36 offen offset:48 sc1
    v_cvt_pk_bf16_f32 v24, v128, v129
    v_cvt_pk_bf16_f32 v25, v130, v131
    buffer_store_dwordx2 v[24:25], v13, s[8:11], s36 offen offset:64 sc1
    v_cvt_pk_bf16_f32 v26, v132, v133
    v_cvt_pk_bf16_f32 v27, v134, v135
    buffer_store_dwordx2 v[26:27], v13, s[8:11], s36 offen offset:80 sc1
    v_cvt_pk_bf16_f32 v28, v136, v137
    v_cvt_pk_bf16_f32 v29, v138, v139
    buffer_store_dwordx2 v[28:29], v13, s[8:11], s36 offen offset:96 sc1
    v_cvt_pk_bf16_f32 v30, v140, v141
    v_cvt_pk_bf16_f32 v31, v142, v143
    buffer_store_dwordx2 v[30:31], v13, s[8:11], s36 offen offset:112 sc1
    s_branch wkv_done
wkv_vpath:
    buffer_load_dwordx4 v[16:19], v10, s[8:11], s48 offen
    buffer_load_dwordx4 v[20:23], v10, s[8:11], s49 offen
    buffer_load_dwordx4 v[24:27], v10, s[8:11], s50 offen
    buffer_load_dwordx4 v[28:31], v10, s[8:11], s51 offen
    buffer_load_dwordx4 v[32:35], v11, s[12:15], s52 offen
    buffer_load_dwordx4 v[36:39], v11, s[12:15], s53 offen
    buffer_load_dwordx4 v[40:43], v11, s[12:15], s54 offen
    buffer_load_dwordx4 v[44:47], v11, s[12:15], s55 offen
    s_add_u32 s48, s48, 128
    s_add_u32 s52, s52, s35
    s_add_u32 s49, s49, 128
    s_add_u32 s53, s53, s35
    s_add_u32 s50, s50, 128
    s_add_u32 s54, s54, s35
    s_add_u32 s51, s51, 128
    s_add_u32 s55, s55, s35
    buffer_load_dwordx4 v[176:179], v10, s[8:11], s48 offen
    buffer_load_dwordx4 v[180:183], v10, s[8:11], s49 offen
    buffer_load_dwordx4 v[184:187], v10, s[8:11], s50 offen
    buffer_load_dwordx4 v[188:191], v10, s[8:11], s51 offen
    buffer_load_dwordx4 v[192:195], v11, s[12:15], s52 offen
    buffer_load_dwordx4 v[196:199], v11, s[12:15], s53 offen
    buffer_load_dwordx4 v[200:203], v11, s[12:15], s54 offen
    buffer_load_dwordx4 v[204:207], v11, s[12:15], s55 offen
    s_add_u32 s48, s48, 128
    s_add_u32 s52, s52, s35
    s_add_u32 s49, s49, 128
    s_add_u32 s53, s53, s35
    s_add_u32 s50, s50, 128
    s_add_u32 s54, s54, s35
    s_add_u32 s51, s51, 128
    s_add_u32 s55, s55, s35
    s_waitcnt vmcnt(8)
    ds_write_b128 v2, v[16:19] offset:0
    ds_write_b128 v2, v[20:23] offset:4608
    ds_write_b128 v2, v[24:27] offset:9216
    ds_write_b128 v2, v[28:31] offset:13824
    ds_write_b128 v3, v[32:35] offset:0
    ds_write_b128 v3, v[36:39] offset:5120
    ds_write_b128 v3, v[40:43] offset:10240
    ds_write_b128 v3, v[44:47] offset:15360
    s_waitcnt lgkmcnt(0)
    s_barrier
    s_mov_b32 s36, 4
gloop_2:
    buffer_load_dwordx4 v[16:19], v10, s[8:11], s48 offen
    buffer_load_dwordx4 v[20:23], v10, s[8:11], s49 offen
    buffer_load_dwordx4 v[24:27], v10, s[8:11], s50 offen
    buffer_load_dwordx4 v[28:31], v10, s[8:11], s51 offen
    buffer_load_dwordx4 v[32:35], v11, s[12:15], s52 offen
    buffer_load_dwordx4 v[36:39], v11, s[12:15], s53 offen
    buffer_load_dwordx4 v[40:43], v11, s[12:15], s54 offen
    buffer_load_dwordx4 v[44:47], v11, s[12:15], s55 offen
    s_add_u32 s48, s48, 128
    s_add_u32 s52, s52, s35
    s_add_u32 s49, s49, 128
    s_add_u32 s53, s53, s35
    s_add_u32 s50, s50, 128
    s_add_u32 s54, s54, s35
    s_add_u32 s51, s51, 128
    s_add_u32 s55, s55, s35
    ds_read_b128 v[48:51], v4 offset:0
    ds_read_b128 v[52:55], v4 offset:4608
    ds_read_b64_tr_b16 v[56:57], v5 offset:0
    ds_read_b64_tr_b16 v[58:59], v5 offset:1280
    ds_read_b64_tr_b16 v[60:61], v5 offset:64
    ds_read_b64_tr_b16 v[62:63], v5 offset:1344
    ds_read_b128 v[64:67], v4 offset:32
    ds_read_b128 v[68:71], v4 offset:4640
    ds_read_b64_tr_b16 v[72:73], v5 offset:5120
    ds_read_b64_tr_b16 v[74:75], v5 offset:6400
    ds_read_b64_tr_b16 v[76:77], v5 offset:5184
    ds_read_b64_tr_b16 v[78:79], v5 offset:6464
    s_waitcnt lgkmcnt(6)
    v_mfma_f32_32x32x16_bf16 v[80:95], v[48:51], v[56:59], v[80:95]
    v_mfma_f32_32x32x16_bf16 v[96:111], v[48:51], v[60:63], v[96:111]
    v_mfma_f32_32x32x16_bf16 v[112:127], v[52:55], v[56:59], v[112:127]
    v_mfma_f32_32x32x16_bf16 v[128:143], v[52:55], v[60:63], v[128:143]
    ds_read_b128 v[48:51], v4 offset:64
    ds_read_b128 v[52:55], v4 offset:4672
    ds_read_b64_tr_b16 v[56:57], v5 offset:10240
    ds_read_b64_tr_b16 v[58:59], v5 offset:11520
    ds_read_b64_tr_b16 v[60:61], v5 offset:10304
    ds_read_b64_tr_b16 v[62:63], v5 offset:11584
    s_waitcnt lgkmcnt(6)
    v_mfma_f32_32x32x16_bf16 v[80:95], v[64:67], v[72:75], v[80:95]
    v_mfma_f32_32x32x16_bf16 v[96:111], v[64:67], v[76:79], v[96:111]
    v_mfma_f32_32x32x16_bf16 v[112:127], v[68:71], v[72:75], v[112:127]
    v_mfma_f32_32x32x16_bf16 v[128:143], v[68:71], v[76:79], v[128:143]
    ds_read_b128 v[64:67], v4 offset:96
    ds_read_b128 v[68:71], v4 offset:4704
    ds_read_b64_tr_b16 v[72:73], v5 offset:15360
    ds_read_b64_tr_b16 v[74:75], v5 offset:16640
    ds_read_b64_tr_b16 v[76:77], v5 offset:15424
    ds_read_b64_tr_b16 v[78:79], v5 offset:16704
    s_waitcnt lgkmcnt(6)
    v_mfma_f32_32x32x16_bf16 v[80:95], v[48:51], v[56:59], v[80:95]
    v_mfma_f32_32x32x16_bf16 v[96:111], v[48:51], v[60:63], v[96:111]
    v_mfma_f32_32x32x16_bf16 v[112:127], v[52:55], v[56:59], v[112:127]
    v_mfma_f32_32x32x16_bf16 v[128:143], v[52:55], v[60:63], v[128:143]
    s_waitcnt lgkmcnt(0)
    v_mfma_f32_32x32x16_bf16 v[80:95], v[64:67], v[72:75], v[80:95]
    v_mfma_f32_32x32x16_bf16 v[96:111], v[64:67], v[76:79], v[96:111]
    v_mfma_f32_32x32x16_bf16 v[112:127], v[68:71], v[72:75], v[112:127]
    v_mfma_f32_32x32x16_bf16 v[128:143], v[68:71], v[76:79], v[128:143]
    s_waitcnt vmcnt(8)
    ds_write_b128 v2, v[176:179] offset:38912
    ds_write_b128 v2, v[180:183] offset:43520
    ds_write_b128 v2, v[184:187] offset:48128
    ds_write_b128 v2, v[188:191] offset:52736
    ds_write_b128 v3, v[192:195] offset:38912
    ds_write_b128 v3, v[196:199] offset:44032
    ds_write_b128 v3, v[200:203] offset:49152
    ds_write_b128 v3, v[204:207] offset:54272
    s_waitcnt lgkmcnt(0)
    s_barrier
    buffer_load_dwordx4 v[176:179], v10, s[8:11], s48 offen
    buffer_load_dwordx4 v[180:183], v10, s[8:11], s49 offen
    buffer_load_dwordx4 v[184:187], v10, s[8:11], s50 offen
    buffer_load_dwordx4 v[188:191], v10, s[8:11], s51 offen
    buffer_load_dwordx4 v[192:195], v11, s[12:15], s52 offen
    buffer_load_dwordx4 v[196:199], v11, s[12:15], s53 offen
    buffer_load_dwordx4 v[200:203], v11, s[12:15], s54 offen
    buffer_load_dwordx4 v[204:207], v11, s[12:15], s55 offen
    s_add_u32 s48, s48, 128
    s_add_u32 s52, s52, s35
    s_add_u32 s49, s49, 128
    s_add_u32 s53, s53, s35
    s_add_u32 s50, s50, 128
    s_add_u32 s54, s54, s35
    s_add_u32 s51, s51, 128
    s_add_u32 s55, s55, s35
    ds_read_b128 v[48:51], v4 offset:38912
    ds_read_b128 v[52:55], v4 offset:43520
    ds_read_b64_tr_b16 v[56:57], v5 offset:38912
    ds_read_b64_tr_b16 v[58:59], v5 offset:40192
    ds_read_b64_tr_b16 v[60:61], v5 offset:38976
    ds_read_b64_tr_b16 v[62:63], v5 offset:40256
    ds_read_b128 v[64:67], v4 offset:38944
    ds_read_b128 v[68:71], v4 offset:43552
    ds_read_b64_tr_b16 v[72:73], v5 offset:44032
    ds_read_b64_tr_b16 v[74:75], v5 offset:45312
    ds_read_b64_tr_b16 v[76:77], v5 offset:44096
    ds_read_b64_tr_b16 v[78:79], v5 offset:45376
    s_waitcnt lgkmcnt(6)
    v_mfma_f32_32x32x16_bf16 v[80:95], v[48:51], v[56:59], v[80:95]
    v_mfma_f32_32x32x16_bf16 v[96:111], v[48:51], v[60:63], v[96:111]
    v_mfma_f32_32x32x16_bf16 v[112:127], v[52:55], v[56:59], v[112:127]
    v_mfma_f32_32x32x16_bf16 v[128:143], v[52:55], v[60:63], v[128:143]
    ds_read_b128 v[48:51], v4 offset:38976
    ds_read_b128 v[52:55], v4 offset:43584
    ds_read_b64_tr_b16 v[56:57], v5 offset:49152
    ds_read_b64_tr_b16 v[58:59], v5 offset:50432
    ds_read_b64_tr_b16 v[60:61], v5 offset:49216
    ds_read_b64_tr_b16 v[62:63], v5 offset:50496
    s_waitcnt lgkmcnt(6)
    v_mfma_f32_32x32x16_bf16 v[80:95], v[64:67], v[72:75], v[80:95]
    v_mfma_f32_32x32x16_bf16 v[96:111], v[64:67], v[76:79], v[96:111]
    v_mfma_f32_32x32x16_bf16 v[112:127], v[68:71], v[72:75], v[112:127]
    v_mfma_f32_32x32x16_bf16 v[128:143], v[68:71], v[76:79], v[128:143]
    ds_read_b128 v[64:67], v4 offset:39008
    ds_read_b128 v[68:71], v4 offset:43616
    ds_read_b64_tr_b16 v[72:73], v5 offset:54272
    ds_read_b64_tr_b16 v[74:75], v5 offset:55552
    ds_read_b64_tr_b16 v[76:77], v5 offset:54336
    ds_read_b64_tr_b16 v[78:79], v5 offset:55616
    s_waitcnt lgkmcnt(6)
    v_mfma_f32_32x32x16_bf16 v[80:95], v[48:51], v[56:59], v[80:95]
    v_mfma_f32_32x32x16_bf16 v[96:111], v[48:51], v[60:63], v[96:111]
    v_mfma_f32_32x32x16_bf16 v[112:127], v[52:55], v[56:59], v[112:127]
    v_mfma_f32_32x32x16_bf16 v[128:143], v[52:55], v[60:63], v[128:143]
    s_waitcnt lgkmcnt(0)
    v_mfma_f32_32x32x16_bf16 v[80:95], v[64:67], v[72:75], v[80:95]
    v_mfma_f32_32x32x16_bf16 v[96:111], v[64:67], v[76:79], v[96:111]
    v_mfma_f32_32x32x16_bf16 v[112:127], v[68:71], v[72:75], v[112:127]
    v_mfma_f32_32x32x16_bf16 v[128:143], v[68:71], v[76:79], v[128:143]
    s_waitcnt vmcnt(8)
    ds_write_b128 v2, v[16:19] offset:0
    ds_write_b128 v2, v[20:23] offset:4608
    ds_write_b128 v2, v[24:27] offset:9216
    ds_write_b128 v2, v[28:31] offset:13824
    ds_write_b128 v3, v[32:35] offset:0
    ds_write_b128 v3, v[36:39] offset:5120
    ds_write_b128 v3, v[40:43] offset:10240
    ds_write_b128 v3, v[44:47] offset:15360
    s_waitcnt lgkmcnt(0)
    s_barrier
    s_sub_u32 s36, s36, 1
    s_cmp_lg_u32 s36, 0
    s_cbranch_scc1 gloop_2
    s_waitcnt vmcnt(0)
    s_nop 7
    s_nop 7
    v_lshlrev_b32 v1, 4, v0
    s_cmp_eq_u32 s59, 0
    s_cbranch_scc1 wkv_vc0
    ds_write_b128 v1, v[80:83] offset:0
    ds_write_b128 v1, v[84:87] offset:4096
    ds_write_b128 v1, v[88:91] offset:8192
    ds_write_b128 v1, v[92:95] offset:12288
    ds_write_b128 v1, v[96:99] offset:16384
    ds_write_b128 v1, v[100:103] offset:20480
    ds_write_b128 v1, v[104:107] offset:24576
    ds_write_b128 v1, v[108:111] offset:28672
    ds_write_b128 v1, v[112:115] offset:32768
    ds_write_b128 v1, v[116:119] offset:36864
    ds_write_b128 v1, v[120:123] offset:40960
    ds_write_b128 v1, v[124:127] offset:45056
    ds_write_b128 v1, v[128:131] offset:49152
    ds_write_b128 v1, v[132:135] offset:53248
    ds_write_b128 v1, v[136:139] offset:57344
    ds_write_b128 v1, v[140:143] offset:61440
wkv_vc0:
    s_waitcnt lgkmcnt(0)
    s_barrier
    s_cmp_lg_u32 s59, 0
    s_cbranch_scc1 wkv_done
    ds_read_b128 v[144:147], v1 offset:0
    ds_read_b128 v[148:151], v1 offset:4096
    ds_read_b128 v[152:155], v1 offset:8192
    ds_read_b128 v[156:159], v1 offset:12288
    ds_read_b128 v[160:163], v1 offset:16384
    ds_read_b128 v[164:167], v1 offset:20480
    ds_read_b128 v[168:171], v1 offset:24576
    ds_read_b128 v[172:175], v1 offset:28672
    s_waitcnt lgkmcnt(0)
    v_add_f32 v80, v80, v144
    v_add_f32 v81, v81, v145
    v_add_f32 v82, v82, v146
    v_add_f32 v83, v83, v147
    v_add_f32 v84, v84, v148
    v_add_f32 v85, v85, v149
    v_add_f32 v86, v86, v150
    v_add_f32 v87, v87, v151
    v_add_f32 v88, v88, v152
    v_add_f32 v89, v89, v153
    v_add_f32 v90, v90, v154
    v_add_f32 v91, v91, v155
    v_add_f32 v92, v92, v156
    v_add_f32 v93, v93, v157
    v_add_f32 v94, v94, v158
    v_add_f32 v95, v95, v159
    v_add_f32 v96, v96, v160
    v_add_f32 v97, v97, v161
    v_add_f32 v98, v98, v162
    v_add_f32 v99, v99, v163
    v_add_f32 v100, v100, v164
    v_add_f32 v101, v101, v165
    v_add_f32 v102, v102, v166
    v_add_f32 v103, v103, v167
    v_add_f32 v104, v104, v168
    v_add_f32 v105, v105, v169
    v_add_f32 v106, v106, v170
    v_add_f32 v107, v107, v171
    v_add_f32 v108, v108, v172
    v_add_f32 v109, v109, v173
    v_add_f32 v110, v110, v174
    v_add_f32 v111, v111, v175
    ds_read_b128 v[144:147], v1 offset:32768
    ds_read_b128 v[148:151], v1 offset:36864
    ds_read_b128 v[152:155], v1 offset:40960
    ds_read_b128 v[156:159], v1 offset:45056
    ds_read_b128 v[160:163], v1 offset:49152
    ds_read_b128 v[164:167], v1 offset:53248
    ds_read_b128 v[168:171], v1 offset:57344
    ds_read_b128 v[172:175], v1 offset:61440
    s_waitcnt lgkmcnt(0)
    v_add_f32 v112, v112, v144
    v_add_f32 v113, v113, v145
    v_add_f32 v114, v114, v146
    v_add_f32 v115, v115, v147
    v_add_f32 v116, v116, v148
    v_add_f32 v117, v117, v149
    v_add_f32 v118, v118, v150
    v_add_f32 v119, v119, v151
    v_add_f32 v120, v120, v152
    v_add_f32 v121, v121, v153
    v_add_f32 v122, v122, v154
    v_add_f32 v123, v123, v155
    v_add_f32 v124, v124, v156
    v_add_f32 v125, v125, v157
    v_add_f32 v126, v126, v158
    v_add_f32 v127, v127, v159
    v_add_f32 v128, v128, v160
    v_add_f32 v129, v129, v161
    v_add_f32 v130, v130, v162
    v_add_f32 v131, v131, v163
    v_add_f32 v132, v132, v164
    v_add_f32 v133, v133, v165
    v_add_f32 v134, v134, v166
    v_add_f32 v135, v135, v167
    v_add_f32 v136, v136, v168
    v_add_f32 v137, v137, v169
    v_add_f32 v138, v138, v170
    v_add_f32 v139, v139, v171
    v_add_f32 v140, v140, v172
    v_add_f32 v141, v141, v173
    v_add_f32 v142, v142, v174
    v_add_f32 v143, v143, v175
    v_lshrrev_b32 v1, 1, v7
    v_lshlrev_b32 v1, 1, v1
    s_lshl_b32 s34, s3, 2
    v_add_u32 v1, s34, v1
    v_lshlrev_b32 v1, 5, v1
    v_add_u32 v1, s33, v1
    v_lshlrev_b32 v1, 7, v1
    v_and_b32 v8, 1, v7
    v_lshlrev_b32 v8, 6, v8
    v_and_b32 v9, 31, v6
    v_add3_u32 v1, v1, v8, v9
    v_lshlrev_b32 v12, 6, v1
    v_lshrrev_b32 v8, 5, v6
    v_lshlrev_b32 v8, 3, v8
    v_add_u32 v12, v12, v8
    v_add_u32 v13, 262144, v12
    s_mov_b32 s36, 41943040
    v_cvt_pk_bf16_f32 v16, v80, v81
    v_cvt_pk_bf16_f32 v17, v82, v83
    buffer_store_dwordx2 v[16:17], v12, s[8:11], s36 offen offset:0 sc1
    v_cvt_pk_bf16_f32 v18, v84, v85
    v_cvt_pk_bf16_f32 v19, v86, v87
    buffer_store_dwordx2 v[18:19], v12, s[8:11], s36 offen offset:16 sc1
    v_cvt_pk_bf16_f32 v20, v88, v89
    v_cvt_pk_bf16_f32 v21, v90, v91
    buffer_store_dwordx2 v[20:21], v12, s[8:11], s36 offen offset:32 sc1
    v_cvt_pk_bf16_f32 v22, v92, v93
    v_cvt_pk_bf16_f32 v23, v94, v95
    buffer_store_dwordx2 v[22:23], v12, s[8:11], s36 offen offset:48 sc1
    v_cvt_pk_bf16_f32 v24, v96, v97
    v_cvt_pk_bf16_f32 v25, v98, v99
    buffer_store_dwordx2 v[24:25], v12, s[8:11], s36 offen offset:2048 sc1
    v_cvt_pk_bf16_f32 v26, v100, v101
    v_cvt_pk_bf16_f32 v27, v102, v103
    buffer_store_dwordx2 v[26:27], v12, s[8:11], s36 offen offset:2064 sc1
    v_cvt_pk_bf16_f32 v28, v104, v105
    v_cvt_pk_bf16_f32 v29, v106, v107
    buffer_store_dwordx2 v[28:29], v12, s[8:11], s36 offen offset:2080 sc1
    v_cvt_pk_bf16_f32 v30, v108, v109
    v_cvt_pk_bf16_f32 v31, v110, v111
    buffer_store_dwordx2 v[30:31], v12, s[8:11], s36 offen offset:2096 sc1
    v_cvt_pk_bf16_f32 v16, v112, v113
    v_cvt_pk_bf16_f32 v17, v114, v115
    buffer_store_dwordx2 v[16:17], v13, s[8:11], s36 offen offset:0 sc1
    v_cvt_pk_bf16_f32 v18, v116, v117
    v_cvt_pk_bf16_f32 v19, v118, v119
    buffer_store_dwordx2 v[18:19], v13, s[8:11], s36 offen offset:16 sc1
    v_cvt_pk_bf16_f32 v20, v120, v121
    v_cvt_pk_bf16_f32 v21, v122, v123
    buffer_store_dwordx2 v[20:21], v13, s[8:11], s36 offen offset:32 sc1
    v_cvt_pk_bf16_f32 v22, v124, v125
    v_cvt_pk_bf16_f32 v23, v126, v127
    buffer_store_dwordx2 v[22:23], v13, s[8:11], s36 offen offset:48 sc1
    v_cvt_pk_bf16_f32 v24, v128, v129
    v_cvt_pk_bf16_f32 v25, v130, v131
    buffer_store_dwordx2 v[24:25], v13, s[8:11], s36 offen offset:2048 sc1
    v_cvt_pk_bf16_f32 v26, v132, v133
    v_cvt_pk_bf16_f32 v27, v134, v135
    buffer_store_dwordx2 v[26:27], v13, s[8:11], s36 offen offset:2064 sc1
    v_cvt_pk_bf16_f32 v28, v136, v137
    v_cvt_pk_bf16_f32 v29, v138, v139
    buffer_store_dwordx2 v[28:29], v13, s[8:11], s36 offen offset:2080 sc1
    v_cvt_pk_bf16_f32 v30, v140, v141
    v_cvt_pk_bf16_f32 v31, v142, v143
    buffer_store_dwordx2 v[30:31], v13, s[8:11], s36 offen offset:2096 sc1
wkv_done:
    s_lshl_b32 s7, s3, 2
    s_waitcnt vmcnt(0)
    s_barrier
    s_cmp_lg_u32 s59, 0
    s_cbranch_scc1 wk_kv_ns
    v_mov_b32 v1, 1
    s_add_u32 s5, s7, 117440512
    v_mov_b32 v2, s5
    v_cmp_eq_u32 vcc, 0, v0
    s_and_saveexec_b64 s[46:47], vcc
    buffer_atomic_add v1, v2, s[8:11], 0 offen sc1
    s_mov_b64 exec, s[46:47]
wk_kv_ns:
    s_barrier
    s_add_u32 s61, s61, 128
    s_branch wk_kv
wk_kv_end:
    s_mov_b32 s61, s60
wk_loop:
    s_cmp_ge_u32 s61, 960
    s_cbranch_scc1 wk_mlp2
    s_and_b32 s3, s61, 15
    s_lshr_b32 s4, s61, 4
    s_add_u32 s5, s4, 96
    s_sub_u32 s6, s4, 28
    s_cmp_lt_u32 s4, 28
    s_cselect_b32 s4, s5, s6
    s_lshr_b32 s5, s4, 5
    s_mov_b32 s40, 18432
    s_cmp_eq_u32 s5, 0
    s_cselect_b32 s6, s16, s18
    s_cselect_b32 s7, s17, s19
    s_cmp_eq_u32 s5, 2
    s_cselect_b32 s6, s20, s6
    s_cselect_b32 s7, s21, s7
    s_cmp_eq_u32 s5, 3
    s_cselect_b32 s6, s24, s6
    s_cselect_b32 s7, s25, s7
    s_mov_b32 s30, 8192
    s_cselect_b32 s30, 7168, s30
    s_mov_b32 s31, 8388608
    s_cselect_b32 s31, 7340032, s31
    s_cselect_b32 s32, 4194304, 0
    s_mov_b32 s12, s6
    s_mov_b32 s13, s7
    s_mov_b32 s14, s31
    s_mov_b32 s15, 0x00020000
    s_mov_b32 s8, s28
    s_mov_b32 s9, s29
    s_mov_b32 s10, 268435456
    s_mov_b32 s11, 0x00020000
    s_and_b32 s33, s4, 31
    v_and_b32 v6, 63, v0
    v_lshrrev_b32 v7, 6, v0
    v_lshrrev_b32 v1, 3, v0
    v_mul_u32_u24 v2, 144, v1
    v_and_b32 v1, 7, v0
    v_lshlrev_b32 v1, 4, v1
    v_add_u32 v2, v2, v1
    v_lshrrev_b32 v1, 4, v0
    v_mul_u32_u24 v3, 320, v1
    v_and_b32 v1, 15, v0
    v_lshlrev_b32 v1, 4, v1
    v_add3_u32 v3, v3, v1, s40
    v_lshrrev_b32 v1, 1, v7
    v_lshlrev_b32 v1, 6, v1
    v_and_b32 v8, 31, v6
    v_add_u32 v1, v1, v8
    v_mul_u32_u24 v4, 144, v1
    v_lshrrev_b32 v1, 5, v6
    v_lshlrev_b32 v1, 4, v1
    v_add_u32 v4, v4, v1
    v_lshrrev_b32 v1, 5, v6
    v_lshlrev_b32 v1, 3, v1
    v_and_b32 v8, 15, v6
    v_lshrrev_b32 v8, 2, v8
    v_add_u32 v1, v1, v8
    v_mul_u32_u24 v5, 320, v1
    v_and_b32 v1, 1, v7
    v_lshlrev_b32 v1, 7, v1
    v_bfe_u32 v8, v6, 4, 1
    v_lshlrev_b32 v8, 5, v8
    v_add_u32 v1, v1, v8
    v_and_b32 v8, 3, v6
    v_lshlrev_b32 v8, 3, v8
    v_add3_u32 v5, v5, v1, v8
    v_add_u32 v5, s40, v5
    v_add_u32 v2, s57, v2
    v_add_u32 v3, s57, v3
    v_add_u32 v4, s57, v4
    v_add_u32 v5, s57, v5
    v_lshrrev_b32 v1, 3, v0
    s_lshl_b32 s34, s3, 7
    v_add_u32 v1, s34, v1
    v_lshlrev_b32 v10, 11, v1
    v_and_b32 v1, 7, v0
    v_lshlrev_b32 v1, 4, v1
    v_add3_u32 v10, v10, v1, s32
    v_lshrrev_b32 v1, 4, v0
    v_mul_lo_u32 v11, v1, s30
    v_and_b32 v1, 15, v0
    v_lshlrev_b32 v1, 4, v1
    s_lshl_b32 s34, s33, 8
    v_add3_u32 v11, v11, v1, s34
    s_mov_b32 s48, 0
    s_mul_i32 s52, s30, 0
    s_mov_b32 s49, 65536
    s_mul_i32 s53, s30, 16
    s_mov_b32 s50, 131072
    s_mul_i32 s54, s30, 32
    s_mov_b32 s51, 196608
    s_mul_i32 s55, s30, 48
    s_lshl_b32 s35, s30, 6
    v_mov_b32 v80, 0
    v_mov_b32 v81, 0
    v_mov_b32 v82, 0
    v_mov_b32 v83, 0
    v_mov_b32 v84, 0
    v_mov_b32 v85, 0
    v_mov_b32 v86, 0
    v_mov_b32 v87, 0
    v_mov_b32 v88, 0
    v_mov_b32 v89, 0
    v_mov_b32 v90, 0
    v_mov_b32 v91, 0
    v_mov_b32 v92, 0
    v_mov_b32 v93, 0
    v_mov_b32 v94, 0
    v_mov_b32 v95, 0
    v_mov_b32 v96, 0
    v_mov_b32 v97, 0
    v_mov_b32 v98, 0
    v_mov_b32 v99, 0
    v_mov_b32 v100, 0
    v_mov_b32 v101, 0
    v_mov_b32 v102, 0
    v_mov_b32 v103, 0
    v_mov_b32 v104, 0
    v_mov_b32 v105, 0
    v_mov_b32 v106, 0
    v_mov_b32 v107, 0
    v_mov_b32 v108, 0
    v_mov_b32 v109, 0
    v_mov_b32 v110, 0
    v_mov_b32 v111, 0
    v_mov_b32 v112, 0
    v_mov_b32 v113, 0
    v_mov_b32 v114, 0
    v_mov_b32 v115, 0
    v_mov_b32 v116, 0
    v_mov_b32 v117, 0
    v_mov_b32 v118, 0
    v_mov_b32 v119, 0
    v_mov_b32 v120, 0
    v_mov_b32 v121, 0
    v_mov_b32 v122, 0
    v_mov_b32 v123, 0
    v_mov_b32 v124, 0
    v_mov_b32 v125, 0
    v_mov_b32 v126, 0
    v_mov_b32 v127, 0
    v_mov_b32 v128, 0
    v_mov_b32 v129, 0
    v_mov_b32 v130, 0
    v_mov_b32 v131, 0
    v_mov_b32 v132, 0
    v_mov_b32 v133, 0
    v_mov_b32 v134, 0
    v_mov_b32 v135, 0
    v_mov_b32 v136, 0
    v_mov_b32 v137, 0
    v_mov_b32 v138, 0
    v_mov_b32 v139, 0
    v_mov_b32 v140, 0
    v_mov_b32 v141, 0
    v_mov_b32 v142, 0
    v_mov_b32 v143, 0
    buffer_load_dwordx4 v[16:19], v10, s[8:11], s48 offen
    buffer_load_dwordx4 v[20:23], v10, s[8:11], s49 offen
    buffer_load_dwordx4 v[24:27], v10, s[8:11], s50 offen
    buffer_load_dwordx4 v[28:31], v10, s[8:11], s51 offen
    buffer_load_dwordx4 v[32:35], v11, s[12:15], s52 offen
    buffer_load_dwordx4 v[36:39], v11, s[12:15], s53 offen
    buffer_load_dwordx4 v[40:43], v11, s[12:15], s54 offen
    buffer_load_dwordx4 v[44:47], v11, s[12:15], s55 offen
    s_add_u32 s48, s48, 128
    s_add_u32 s52, s52, s35
    s_add_u32 s49, s49, 128
    s_add_u32 s53, s53, s35
    s_add_u32 s50, s50, 128
    s_add_u32 s54, s54, s35
    s_add_u32 s51, s51, 128
    s_add_u32 s55, s55, s35
    buffer_load_dwordx4 v[176:179], v10, s[8:11], s48 offen
    buffer_load_dwordx4 v[180:183], v10, s[8:11], s49 offen
    buffer_load_dwordx4 v[184:187], v10, s[8:11], s50 offen
    buffer_load_dwordx4 v[188:191], v10, s[8:11], s51 offen
    buffer_load_dwordx4 v[192:195], v11, s[12:15], s52 offen
    buffer_load_dwordx4 v[196:199], v11, s[12:15], s53 offen
    buffer_load_dwordx4 v[200:203], v11, s[12:15], s54 offen
    buffer_load_dwordx4 v[204:207], v11, s[12:15], s55 offen
    s_add_u32 s48, s48, 128
    s_add_u32 s52, s52, s35
    s_add_u32 s49, s49, 128
    s_add_u32 s53, s53, s35
    s_add_u32 s50, s50, 128
    s_add_u32 s54, s54, s35
    s_add_u32 s51, s51, 128
    s_add_u32 s55, s55, s35
    s_waitcnt vmcnt(8)
    ds_write_b128 v2, v[16:19] offset:0
    ds_write_b128 v2, v[20:23] offset:4608
    ds_write_b128 v2, v[24:27] offset:9216
    ds_write_b128 v2, v[28:31] offset:13824
    ds_write_b128 v3, v[32:35] offset:0
    ds_write_b128 v3, v[36:39] offset:5120
    ds_write_b128 v3, v[40:43] offset:10240
    ds_write_b128 v3, v[44:47] offset:15360
    s_waitcnt lgkmcnt(0)
    s_barrier
    s_mov_b32 s36, 8
gloop_3:
    buffer_load_dwordx4 v[16:19], v10, s[8:11], s48 offen
    buffer_load_dwordx4 v[20:23], v10, s[8:11], s49 offen
    buffer_load_dwordx4 v[24:27], v10, s[8:11], s50 offen
    buffer_load_dwordx4 v[28:31], v10, s[8:11], s51 offen
    buffer_load_dwordx4 v[32:35], v11, s[12:15], s52 offen
    buffer_load_dwordx4 v[36:39], v11, s[12:15], s53 offen
    buffer_load_dwordx4 v[40:43], v11, s[12:15], s54 offen
    buffer_load_dwordx4 v[44:47], v11, s[12:15], s55 offen
    s_add_u32 s48, s48, 128
    s_add_u32 s52, s52, s35
    s_add_u32 s49, s49, 128
    s_add_u32 s53, s53, s35
    s_add_u32 s50, s50, 128
    s_add_u32 s54, s54, s35
    s_add_u32 s51, s51, 128
    s_add_u32 s55, s55, s35
    ds_read_b128 v[48:51], v4 offset:0
    ds_read_b128 v[52:55], v4 offset:4608
    ds_read_b64_tr_b16 v[56:57], v5 offset:0
    ds_read_b64_tr_b16 v[58:59], v5 offset:1280
    ds_read_b64_tr_b16 v[60:61], v5 offset:64
    ds_read_b64_tr_b16 v[62:63], v5 offset:1344
    ds_read_b128 v[64:67], v4 offset:32
    ds_read_b128 v[68:71], v4 offset:4640
    ds_read_b64_tr_b16 v[72:73], v5 offset:5120
    ds_read_b64_tr_b16 v[74:75], v5 offset:6400
    ds_read_b64_tr_b16 v[76:77], v5 offset:5184
    ds_read_b64_tr_b16 v[78:79], v5 offset:6464
    s_waitcnt lgkmcnt(6)
    v_mfma_f32_32x32x16_bf16 v[80:95], v[56:59], v[48:51], v[80:95]
    v_mfma_f32_32x32x16_bf16 v[96:111], v[60:63], v[48:51], v[96:111]
    v_mfma_f32_32x32x16_bf16 v[112:127], v[56:59], v[52:55], v[112:127]
    v_mfma_f32_32x32x16_bf16 v[128:143], v[60:63], v[52:55], v[128:143]
    ds_read_b128 v[48:51], v4 offset:64
    ds_read_b128 v[52:55], v4 offset:4672
    ds_read_b64_tr_b16 v[56:57], v5 offset:10240
    ds_read_b64_tr_b16 v[58:59], v5 offset:11520
    ds_read_b64_tr_b16 v[60:61], v5 offset:10304
    ds_read_b64_tr_b16 v[62:63], v5 offset:11584
    s_waitcnt lgkmcnt(6)
    v_mfma_f32_32x32x16_bf16 v[80:95], v[72:75], v[64:67], v[80:95]
    v_mfma_f32_32x32x16_bf16 v[96:111], v[76:79], v[64:67], v[96:111]
    v_mfma_f32_32x32x16_bf16 v[112:127], v[72:75], v[68:71], v[112:127]
    v_mfma_f32_32x32x16_bf16 v[128:143], v[76:79], v[68:71], v[128:143]
    ds_read_b128 v[64:67], v4 offset:96
    ds_read_b128 v[68:71], v4 offset:4704
    ds_read_b64_tr_b16 v[72:73], v5 offset:15360
    ds_read_b64_tr_b16 v[74:75], v5 offset:16640
    ds_read_b64_tr_b16 v[76:77], v5 offset:15424
    ds_read_b64_tr_b16 v[78:79], v5 offset:16704
    s_waitcnt lgkmcnt(6)
    v_mfma_f32_32x32x16_bf16 v[80:95], v[56:59], v[48:51], v[80:95]
    v_mfma_f32_32x32x16_bf16 v[96:111], v[60:63], v[48:51], v[96:111]
    v_mfma_f32_32x32x16_bf16 v[112:127], v[56:59], v[52:55], v[112:127]
    v_mfma_f32_32x32x16_bf16 v[128:143], v[60:63], v[52:55], v[128:143]
    s_waitcnt lgkmcnt(0)
    v_mfma_f32_32x32x16_bf16 v[80:95], v[72:75], v[64:67], v[80:95]
    v_mfma_f32_32x32x16_bf16 v[96:111], v[76:79], v[64:67], v[96:111]
    v_mfma_f32_32x32x16_bf16 v[112:127], v[72:75], v[68:71], v[112:127]
    v_mfma_f32_32x32x16_bf16 v[128:143], v[76:79], v[68:71], v[128:143]
    s_waitcnt vmcnt(8)
    ds_write_b128 v2, v[176:179] offset:38912
    ds_write_b128 v2, v[180:183] offset:43520
    ds_write_b128 v2, v[184:187] offset:48128
    ds_write_b128 v2, v[188:191] offset:52736
    ds_write_b128 v3, v[192:195] offset:38912
    ds_write_b128 v3, v[196:199] offset:44032
    ds_write_b128 v3, v[200:203] offset:49152
    ds_write_b128 v3, v[204:207] offset:54272
    s_waitcnt lgkmcnt(0)
    s_barrier
    buffer_load_dwordx4 v[176:179], v10, s[8:11], s48 offen
    buffer_load_dwordx4 v[180:183], v10, s[8:11], s49 offen
    buffer_load_dwordx4 v[184:187], v10, s[8:11], s50 offen
    buffer_load_dwordx4 v[188:191], v10, s[8:11], s51 offen
    buffer_load_dwordx4 v[192:195], v11, s[12:15], s52 offen
    buffer_load_dwordx4 v[196:199], v11, s[12:15], s53 offen
    buffer_load_dwordx4 v[200:203], v11, s[12:15], s54 offen
    buffer_load_dwordx4 v[204:207], v11, s[12:15], s55 offen
    s_add_u32 s48, s48, 128
    s_add_u32 s52, s52, s35
    s_add_u32 s49, s49, 128
    s_add_u32 s53, s53, s35
    s_add_u32 s50, s50, 128
    s_add_u32 s54, s54, s35
    s_add_u32 s51, s51, 128
    s_add_u32 s55, s55, s35
    ds_read_b128 v[48:51], v4 offset:38912
    ds_read_b128 v[52:55], v4 offset:43520
    ds_read_b64_tr_b16 v[56:57], v5 offset:38912
    ds_read_b64_tr_b16 v[58:59], v5 offset:40192
    ds_read_b64_tr_b16 v[60:61], v5 offset:38976
    ds_read_b64_tr_b16 v[62:63], v5 offset:40256
    ds_read_b128 v[64:67], v4 offset:38944
    ds_read_b128 v[68:71], v4 offset:43552
    ds_read_b64_tr_b16 v[72:73], v5 offset:44032
    ds_read_b64_tr_b16 v[74:75], v5 offset:45312
    ds_read_b64_tr_b16 v[76:77], v5 offset:44096
    ds_read_b64_tr_b16 v[78:79], v5 offset:45376
    s_waitcnt lgkmcnt(6)
    v_mfma_f32_32x32x16_bf16 v[80:95], v[56:59], v[48:51], v[80:95]
    v_mfma_f32_32x32x16_bf16 v[96:111], v[60:63], v[48:51], v[96:111]
    v_mfma_f32_32x32x16_bf16 v[112:127], v[56:59], v[52:55], v[112:127]
    v_mfma_f32_32x32x16_bf16 v[128:143], v[60:63], v[52:55], v[128:143]
    ds_read_b128 v[48:51], v4 offset:38976
    ds_read_b128 v[52:55], v4 offset:43584
    ds_read_b64_tr_b16 v[56:57], v5 offset:49152
    ds_read_b64_tr_b16 v[58:59], v5 offset:50432
    ds_read_b64_tr_b16 v[60:61], v5 offset:49216
    ds_read_b64_tr_b16 v[62:63], v5 offset:50496
    s_waitcnt lgkmcnt(6)
    v_mfma_f32_32x32x16_bf16 v[80:95], v[72:75], v[64:67], v[80:95]
    v_mfma_f32_32x32x16_bf16 v[96:111], v[76:79], v[64:67], v[96:111]
    v_mfma_f32_32x32x16_bf16 v[112:127], v[72:75], v[68:71], v[112:127]
    v_mfma_f32_32x32x16_bf16 v[128:143], v[76:79], v[68:71], v[128:143]
    ds_read_b128 v[64:67], v4 offset:39008
    ds_read_b128 v[68:71], v4 offset:43616
    ds_read_b64_tr_b16 v[72:73], v5 offset:54272
    ds_read_b64_tr_b16 v[74:75], v5 offset:55552
    ds_read_b64_tr_b16 v[76:77], v5 offset:54336
    ds_read_b64_tr_b16 v[78:79], v5 offset:55616
    s_waitcnt lgkmcnt(6)
    v_mfma_f32_32x32x16_bf16 v[80:95], v[56:59], v[48:51], v[80:95]
    v_mfma_f32_32x32x16_bf16 v[96:111], v[60:63], v[48:51], v[96:111]
    v_mfma_f32_32x32x16_bf16 v[112:127], v[56:59], v[52:55], v[112:127]
    v_mfma_f32_32x32x16_bf16 v[128:143], v[60:63], v[52:55], v[128:143]
    s_waitcnt lgkmcnt(0)
    v_mfma_f32_32x32x16_bf16 v[80:95], v[72:75], v[64:67], v[80:95]
    v_mfma_f32_32x32x16_bf16 v[96:111], v[76:79], v[64:67], v[96:111]
    v_mfma_f32_32x32x16_bf16 v[112:127], v[72:75], v[68:71], v[112:127]
    v_mfma_f32_32x32x16_bf16 v[128:143], v[76:79], v[68:71], v[128:143]
    s_waitcnt vmcnt(8)
    ds_write_b128 v2, v[16:19] offset:0
    ds_write_b128 v2, v[20:23] offset:4608
    ds_write_b128 v2, v[24:27] offset:9216
    ds_write_b128 v2, v[28:31] offset:13824
    ds_write_b128 v3, v[32:35] offset:0
    ds_write_b128 v3, v[36:39] offset:5120
    ds_write_b128 v3, v[40:43] offset:10240
    ds_write_b128 v3, v[44:47] offset:15360
    s_waitcnt lgkmcnt(0)
    s_barrier
    s_sub_u32 s36, s36, 1
    s_cmp_lg_u32 s36, 0
    s_cbranch_scc1 gloop_3
    s_waitcnt vmcnt(0)
    s_nop 7
    s_nop 7
    s_cmp_eq_u32 s5, 3
    s_cbranch_scc1 wk_mlp
    s_cmp_eq_u32 s5, 0
    s_mov_b32 s36, 25165824
    s_cselect_b32 s36, 8388608, s36
    v_lshrrev_b32 v1, 1, v7
    v_lshlrev_b32 v1, 6, v1
    v_and_b32 v8, 31, v6
    s_lshl_b32 s34, s3, 7
    v_add3_u32 v1, v1, v8, s34
    v_lshlrev_b32 v12, 13, v1
    v_and_b32 v1, 1, v7
    v_lshlrev_b32 v1, 7, v1
    v_lshrrev_b32 v8, 5, v6
    v_lshlrev_b32 v8, 3, v8
    s_lshl_b32 s34, s33, 8
    v_add3_u32 v1, v1, v8, s34
    v_add_u32 v12, v12, v1
    v_add_u32 v13, 0x40000, v12
    v_cvt_pk_bf16_f32 v16, v80, v81
    v_cvt_pk_bf16_f32 v17, v82, v83
    buffer_store_dwordx2 v[16:17], v12, s[8:11], s36 offen offset:0 sc1
    v_cvt_pk_bf16_f32 v18, v84, v85
    v_cvt_pk_bf16_f32 v19, v86, v87
    buffer_store_dwordx2 v[18:19], v12, s[8:11], s36 offen offset:16 sc1
    v_cvt_pk_bf16_f32 v20, v88, v89
    v_cvt_pk_bf16_f32 v21, v90, v91
    buffer_store_dwordx2 v[20:21], v12, s[8:11], s36 offen offset:32 sc1
    v_cvt_pk_bf16_f32 v22, v92, v93
    v_cvt_pk_bf16_f32 v23, v94, v95
    buffer_store_dwordx2 v[22:23], v12, s[8:11], s36 offen offset:48 sc1
    v_cvt_pk_bf16_f32 v24, v96, v97
    v_cvt_pk_bf16_f32 v25, v98, v99
    buffer_store_dwordx2 v[24:25], v12, s[8:11], s36 offen offset:64 sc1
    v_cvt_pk_bf16_f32 v26, v100, v101
    v_cvt_pk_bf16_f32 v27, v102, v103
    buffer_store_dwordx2 v[26:27], v12, s[8:11], s36 offen offset:80 sc1
    v_cvt_pk_bf16_f32 v28, v104, v105
    v_cvt_pk_bf16_f32 v29, v106, v107
    buffer_store_dwordx2 v[28:29], v12, s[8:11], s36 offen offset:96 sc1
    v_cvt_pk_bf16_f32 v30, v108, v109
    v_cvt_pk_bf16_f32 v31, v110, v111
    buffer_store_dwordx2 v[30:31], v12, s[8:11], s36 offen offset:112 sc1
    v_cvt_pk_bf16_f32 v16, v112, v113
    v_cvt_pk_bf16_f32 v17, v114, v115
    buffer_store_dwordx2 v[16:17], v13, s[8:11], s36 offen offset:0 sc1
    v_cvt_pk_bf16_f32 v18, v116, v117
    v_cvt_pk_bf16_f32 v19, v118, v119
    buffer_store_dwordx2 v[18:19], v13, s[8:11], s36 offen offset:16 sc1
    v_cvt_pk_bf16_f32 v20, v120, v121
    v_cvt_pk_bf16_f32 v21, v122, v123
    buffer_store_dwordx2 v[20:21], v13, s[8:11], s36 offen offset:32 sc1
    v_cvt_pk_bf16_f32 v22, v124, v125
    v_cvt_pk_bf16_f32 v23, v126, v127
    buffer_store_dwordx2 v[22:23], v13, s[8:11], s36 offen offset:48 sc1
    v_cvt_pk_bf16_f32 v24, v128, v129
    v_cvt_pk_bf16_f32 v25, v130, v131
    buffer_store_dwordx2 v[24:25], v13, s[8:11], s36 offen offset:64 sc1
    v_cvt_pk_bf16_f32 v26, v132, v133
    v_cvt_pk_bf16_f32 v27, v134, v135
    buffer_store_dwordx2 v[26:27], v13, s[8:11], s36 offen offset:80 sc1
    v_cvt_pk_bf16_f32 v28, v136, v137
    v_cvt_pk_bf16_f32 v29, v138, v139
    buffer_store_dwordx2 v[28:29], v13, s[8:11], s36 offen offset:96 sc1
    v_cvt_pk_bf16_f32 v30, v140, v141
    v_cvt_pk_bf16_f32 v31, v142, v143
    buffer_store_dwordx2 v[30:31], v13, s[8:11], s36 offen offset:112 sc1
    s_branch wk_done
wk_mlp:
    s_mov_b32 s40, s26
    s_mov_b32 s41, s27
    s_mov_b32 s42, 7168
    s_mov_b32 s43, 0x00020000
    s_mov_b32 s44, 0x3d372713
    s_mov_b32 s45, 0xc0135761
    v_lshrrev_b32 v1, 1, v7
    v_lshlrev_b32 v1, 6, v1
    v_and_b32 v8, 31, v6
    s_lshl_b32 s34, s3, 7
    v_add3_u32 v1, v1, v8, s34
    s_mov_b32 s34, 7168
    v_mul_lo_u32 v12, v1, s34
    v_and_b32 v1, 1, v7
    v_lshlrev_b32 v1, 7, v1
    v_lshrrev_b32 v8, 5, v6
    v_lshlrev_b32 v8, 3, v8
    s_lshl_b32 s34, s33, 8
    v_add3_u32 v14, v1, v8, s34
    v_add_u32 v12, v12, v14
    v_add_u32 v13, 229376, v12
    s_mov_b32 s36, 58720256
    buffer_load_dwordx2 v[16:17], v14, s[40:43], 0 offen offset:0
    buffer_load_dwordx2 v[18:19], v14, s[40:43], 0 offen offset:16
    buffer_load_dwordx2 v[20:21], v14, s[40:43], 0 offen offset:32
    buffer_load_dwordx2 v[22:23], v14, s[40:43], 0 offen offset:48
    buffer_load_dwordx2 v[24:25], v14, s[40:43], 0 offen offset:64
    buffer_load_dwordx2 v[26:27], v14, s[40:43], 0 offen offset:80
    buffer_load_dwordx2 v[28:29], v14, s[40:43], 0 offen offset:96
    buffer_load_dwordx2 v[30:31], v14, s[40:43], 0 offen offset:112
    s_waitcnt vmcnt(0)
    v_cvt_pk_bf16_f32 v80, v80, v80
    v_lshlrev_b32 v80, 16, v80
    v_lshlrev_b32 v32, 16, v16
    v_add_f32 v80, v80, v32
    v_cvt_pk_bf16_f32 v80, v80, v80
    v_lshlrev_b32 v80, 16, v80
    v_mul_f32 v33, v80, v80
    v_mul_f32 v33, v33, v80
    v_fma_f32 v33, v33, s44, v80
    v_mul_f32 v33, s45, v33
    v_exp_f32 v33, v33
    s_nop 0
    v_add_f32 v33, 1.0, v33
    v_rcp_f32 v33, v33
    s_nop 0
    v_mul_f32 v80, v80, v33
    v_cvt_pk_bf16_f32 v81, v81, v81
    v_lshlrev_b32 v81, 16, v81
    v_and_b32 v32, 0xffff0000, v16
    v_add_f32 v81, v81, v32
    v_cvt_pk_bf16_f32 v81, v81, v81
    v_lshlrev_b32 v81, 16, v81
    v_mul_f32 v33, v81, v81
    v_mul_f32 v33, v33, v81
    v_fma_f32 v33, v33, s44, v81
    v_mul_f32 v33, s45, v33
    v_exp_f32 v33, v33
    s_nop 0
    v_add_f32 v33, 1.0, v33
    v_rcp_f32 v33, v33
    s_nop 0
    v_mul_f32 v81, v81, v33
    v_cvt_pk_bf16_f32 v82, v82, v82
    v_lshlrev_b32 v82, 16, v82
    v_lshlrev_b32 v32, 16, v17
    v_add_f32 v82, v82, v32
    v_cvt_pk_bf16_f32 v82, v82, v82
    v_lshlrev_b32 v82, 16, v82
    v_mul_f32 v33, v82, v82
    v_mul_f32 v33, v33, v82
    v_fma_f32 v33, v33, s44, v82
    v_mul_f32 v33, s45, v33
    v_exp_f32 v33, v33
    s_nop 0
    v_add_f32 v33, 1.0, v33
    v_rcp_f32 v33, v33
    s_nop 0
    v_mul_f32 v82, v82, v33
    v_cvt_pk_bf16_f32 v83, v83, v83
    v_lshlrev_b32 v83, 16, v83
    v_and_b32 v32, 0xffff0000, v17
    v_add_f32 v83, v83, v32
    v_cvt_pk_bf16_f32 v83, v83, v83
    v_lshlrev_b32 v83, 16, v83
    v_mul_f32 v33, v83, v83
    v_mul_f32 v33, v33, v83
    v_fma_f32 v33, v33, s44, v83
    v_mul_f32 v33, s45, v33
    v_exp_f32 v33, v33
    s_nop 0
    v_add_f32 v33, 1.0, v33
    v_rcp_f32 v33, v33
    s_nop 0
    v_mul_f32 v83, v83, v33
    v_cvt_pk_bf16_f32 v36, v80, v81
    v_cvt_pk_bf16_f32 v37, v82, v83
    buffer_store_dwordx2 v[36:37], v12, s[8:11], s36 offen offset:0 sc1
    s_nop 1
    v_cvt_pk_bf16_f32 v84, v84, v84
    v_lshlrev_b32 v84, 16, v84
    v_lshlrev_b32 v32, 16, v18
    v_add_f32 v84, v84, v32
    v_cvt_pk_bf16_f32 v84, v84, v84
    v_lshlrev_b32 v84, 16, v84
    v_mul_f32 v33, v84, v84
    v_mul_f32 v33, v33, v84
    v_fma_f32 v33, v33, s44, v84
    v_mul_f32 v33, s45, v33
    v_exp_f32 v33, v33
    s_nop 0
    v_add_f32 v33, 1.0, v33
    v_rcp_f32 v33, v33
    s_nop 0
    v_mul_f32 v84, v84, v33
    v_cvt_pk_bf16_f32 v85, v85, v85
    v_lshlrev_b32 v85, 16, v85
    v_and_b32 v32, 0xffff0000, v18
    v_add_f32 v85, v85, v32
    v_cvt_pk_bf16_f32 v85, v85, v85
    v_lshlrev_b32 v85, 16, v85
    v_mul_f32 v33, v85, v85
    v_mul_f32 v33, v33, v85
    v_fma_f32 v33, v33, s44, v85
    v_mul_f32 v33, s45, v33
    v_exp_f32 v33, v33
    s_nop 0
    v_add_f32 v33, 1.0, v33
    v_rcp_f32 v33, v33
    s_nop 0
    v_mul_f32 v85, v85, v33
    v_cvt_pk_bf16_f32 v86, v86, v86
    v_lshlrev_b32 v86, 16, v86
    v_lshlrev_b32 v32, 16, v19
    v_add_f32 v86, v86, v32
    v_cvt_pk_bf16_f32 v86, v86, v86
    v_lshlrev_b32 v86, 16, v86
    v_mul_f32 v33, v86, v86
    v_mul_f32 v33, v33, v86
    v_fma_f32 v33, v33, s44, v86
    v_mul_f32 v33, s45, v33
    v_exp_f32 v33, v33
    s_nop 0
    v_add_f32 v33, 1.0, v33
    v_rcp_f32 v33, v33
    s_nop 0
    v_mul_f32 v86, v86, v33
    v_cvt_pk_bf16_f32 v87, v87, v87
    v_lshlrev_b32 v87, 16, v87
    v_and_b32 v32, 0xffff0000, v19
    v_add_f32 v87, v87, v32
    v_cvt_pk_bf16_f32 v87, v87, v87
    v_lshlrev_b32 v87, 16, v87
    v_mul_f32 v33, v87, v87
    v_mul_f32 v33, v33, v87
    v_fma_f32 v33, v33, s44, v87
    v_mul_f32 v33, s45, v33
    v_exp_f32 v33, v33
    s_nop 0
    v_add_f32 v33, 1.0, v33
    v_rcp_f32 v33, v33
    s_nop 0
    v_mul_f32 v87, v87, v33
    v_cvt_pk_bf16_f32 v36, v84, v85
    v_cvt_pk_bf16_f32 v37, v86, v87
    buffer_store_dwordx2 v[36:37], v12, s[8:11], s36 offen offset:16 sc1
    s_nop 1
    v_cvt_pk_bf16_f32 v88, v88, v88
    v_lshlrev_b32 v88, 16, v88
    v_lshlrev_b32 v32, 16, v20
    v_add_f32 v88, v88, v32
    v_cvt_pk_bf16_f32 v88, v88, v88
    v_lshlrev_b32 v88, 16, v88
    v_mul_f32 v33, v88, v88
    v_mul_f32 v33, v33, v88
    v_fma_f32 v33, v33, s44, v88
    v_mul_f32 v33, s45, v33
    v_exp_f32 v33, v33
    s_nop 0
    v_add_f32 v33, 1.0, v33
    v_rcp_f32 v33, v33
    s_nop 0
    v_mul_f32 v88, v88, v33
    v_cvt_pk_bf16_f32 v89, v89, v89
    v_lshlrev_b32 v89, 16, v89
    v_and_b32 v32, 0xffff0000, v20
    v_add_f32 v89, v89, v32
    v_cvt_pk_bf16_f32 v89, v89, v89
    v_lshlrev_b32 v89, 16, v89
    v_mul_f32 v33, v89, v89
    v_mul_f32 v33, v33, v89
    v_fma_f32 v33, v33, s44, v89
    v_mul_f32 v33, s45, v33
    v_exp_f32 v33, v33
    s_nop 0
    v_add_f32 v33, 1.0, v33
    v_rcp_f32 v33, v33
    s_nop 0
    v_mul_f32 v89, v89, v33
    v_cvt_pk_bf16_f32 v90, v90, v90
    v_lshlrev_b32 v90, 16, v90
    v_lshlrev_b32 v32, 16, v21
    v_add_f32 v90, v90, v32
    v_cvt_pk_bf16_f32 v90, v90, v90
    v_lshlrev_b32 v90, 16, v90
    v_mul_f32 v33, v90, v90
    v_mul_f32 v33, v33, v90
    v_fma_f32 v33, v33, s44, v90
    v_mul_f32 v33, s45, v33
    v_exp_f32 v33, v33
    s_nop 0
    v_add_f32 v33, 1.0, v33
    v_rcp_f32 v33, v33
    s_nop 0
    v_mul_f32 v90, v90, v33
    v_cvt_pk_bf16_f32 v91, v91, v91
    v_lshlrev_b32 v91, 16, v91
    v_and_b32 v32, 0xffff0000, v21
    v_add_f32 v91, v91, v32
    v_cvt_pk_bf16_f32 v91, v91, v91
    v_lshlrev_b32 v91, 16, v91
    v_mul_f32 v33, v91, v91
    v_mul_f32 v33, v33, v91
    v_fma_f32 v33, v33, s44, v91
    v_mul_f32 v33, s45, v33
    v_exp_f32 v33, v33
    s_nop 0
    v_add_f32 v33, 1.0, v33
    v_rcp_f32 v33, v33
    s_nop 0
    v_mul_f32 v91, v91, v33
    v_cvt_pk_bf16_f32 v36, v88, v89
    v_cvt_pk_bf16_f32 v37, v90, v91
    buffer_store_dwordx2 v[36:37], v12, s[8:11], s36 offen offset:32 sc1
    s_nop 1
    v_cvt_pk_bf16_f32 v92, v92, v92
    v_lshlrev_b32 v92, 16, v92
    v_lshlrev_b32 v32, 16, v22
    v_add_f32 v92, v92, v32
    v_cvt_pk_bf16_f32 v92, v92, v92
    v_lshlrev_b32 v92, 16, v92
    v_mul_f32 v33, v92, v92
    v_mul_f32 v33, v33, v92
    v_fma_f32 v33, v33, s44, v92
    v_mul_f32 v33, s45, v33
    v_exp_f32 v33, v33
    s_nop 0
    v_add_f32 v33, 1.0, v33
    v_rcp_f32 v33, v33
    s_nop 0
    v_mul_f32 v92, v92, v33
    v_cvt_pk_bf16_f32 v93, v93, v93
    v_lshlrev_b32 v93, 16, v93
    v_and_b32 v32, 0xffff0000, v22
    v_add_f32 v93, v93, v32
    v_cvt_pk_bf16_f32 v93, v93, v93
    v_lshlrev_b32 v93, 16, v93
    v_mul_f32 v33, v93, v93
    v_mul_f32 v33, v33, v93
    v_fma_f32 v33, v33, s44, v93
    v_mul_f32 v33, s45, v33
    v_exp_f32 v33, v33
    s_nop 0
    v_add_f32 v33, 1.0, v33
    v_rcp_f32 v33, v33
    s_nop 0
    v_mul_f32 v93, v93, v33
    v_cvt_pk_bf16_f32 v94, v94, v94
    v_lshlrev_b32 v94, 16, v94
    v_lshlrev_b32 v32, 16, v23
    v_add_f32 v94, v94, v32
    v_cvt_pk_bf16_f32 v94, v94, v94
    v_lshlrev_b32 v94, 16, v94
    v_mul_f32 v33, v94, v94
    v_mul_f32 v33, v33, v94
    v_fma_f32 v33, v33, s44, v94
    v_mul_f32 v33, s45, v33
    v_exp_f32 v33, v33
    s_nop 0
    v_add_f32 v33, 1.0, v33
    v_rcp_f32 v33, v33
    s_nop 0
    v_mul_f32 v94, v94, v33
    v_cvt_pk_bf16_f32 v95, v95, v95
    v_lshlrev_b32 v95, 16, v95
    v_and_b32 v32, 0xffff0000, v23
    v_add_f32 v95, v95, v32
    v_cvt_pk_bf16_f32 v95, v95, v95
    v_lshlrev_b32 v95, 16, v95
    v_mul_f32 v33, v95, v95
    v_mul_f32 v33, v33, v95
    v_fma_f32 v33, v33, s44, v95
    v_mul_f32 v33, s45, v33
    v_exp_f32 v33, v33
    s_nop 0
    v_add_f32 v33, 1.0, v33
    v_rcp_f32 v33, v33
    s_nop 0
    v_mul_f32 v95, v95, v33
    v_cvt_pk_bf16_f32 v36, v92, v93
    v_cvt_pk_bf16_f32 v37, v94, v95
    buffer_store_dwordx2 v[36:37], v12, s[8:11], s36 offen offset:48 sc1
    s_nop 1
    v_cvt_pk_bf16_f32 v96, v96, v96
    v_lshlrev_b32 v96, 16, v96
    v_lshlrev_b32 v32, 16, v24
    v_add_f32 v96, v96, v32
    v_cvt_pk_bf16_f32 v96, v96, v96
    v_lshlrev_b32 v96, 16, v96
    v_mul_f32 v33, v96, v96
    v_mul_f32 v33, v33, v96
    v_fma_f32 v33, v33, s44, v96
    v_mul_f32 v33, s45, v33
    v_exp_f32 v33, v33
    s_nop 0
    v_add_f32 v33, 1.0, v33
    v_rcp_f32 v33, v33
    s_nop 0
    v_mul_f32 v96, v96, v33
    v_cvt_pk_bf16_f32 v97, v97, v97
    v_lshlrev_b32 v97, 16, v97
    v_and_b32 v32, 0xffff0000, v24
    v_add_f32 v97, v97, v32
    v_cvt_pk_bf16_f32 v97, v97, v97
    v_lshlrev_b32 v97, 16, v97
    v_mul_f32 v33, v97, v97
    v_mul_f32 v33, v33, v97
    v_fma_f32 v33, v33, s44, v97
    v_mul_f32 v33, s45, v33
    v_exp_f32 v33, v33
    s_nop 0
    v_add_f32 v33, 1.0, v33
    v_rcp_f32 v33, v33
    s_nop 0
    v_mul_f32 v97, v97, v33
    v_cvt_pk_bf16_f32 v98, v98, v98
    v_lshlrev_b32 v98, 16, v98
    v_lshlrev_b32 v32, 16, v25
    v_add_f32 v98, v98, v32
    v_cvt_pk_bf16_f32 v98, v98, v98
    v_lshlrev_b32 v98, 16, v98
    v_mul_f32 v33, v98, v98
    v_mul_f32 v33, v33, v98
    v_fma_f32 v33, v33, s44, v98
    v_mul_f32 v33, s45, v33
    v_exp_f32 v33, v33
    s_nop 0
    v_add_f32 v33, 1.0, v33
    v_rcp_f32 v33, v33
    s_nop 0
    v_mul_f32 v98, v98, v33
    v_cvt_pk_bf16_f32 v99, v99, v99
    v_lshlrev_b32 v99, 16, v99
    v_and_b32 v32, 0xffff0000, v25
    v_add_f32 v99, v99, v32
    v_cvt_pk_bf16_f32 v99, v99, v99
    v_lshlrev_b32 v99, 16, v99
    v_mul_f32 v33, v99, v99
    v_mul_f32 v33, v33, v99
    v_fma_f32 v33, v33, s44, v99
    v_mul_f32 v33, s45, v33
    v_exp_f32 v33, v33
    s_nop 0
    v_add_f32 v33, 1.0, v33
    v_rcp_f32 v33, v33
    s_nop 0
    v_mul_f32 v99, v99, v33
    v_cvt_pk_bf16_f32 v36, v96, v97
    v_cvt_pk_bf16_f32 v37, v98, v99
    buffer_store_dwordx2 v[36:37], v12, s[8:11], s36 offen offset:64 sc1
    s_nop 1
    v_cvt_pk_bf16_f32 v100, v100, v100
    v_lshlrev_b32 v100, 16, v100
    v_lshlrev_b32 v32, 16, v26
    v_add_f32 v100, v100, v32
    v_cvt_pk_bf16_f32 v100, v100, v100
    v_lshlrev_b32 v100, 16, v100
    v_mul_f32 v33, v100, v100
    v_mul_f32 v33, v33, v100
    v_fma_f32 v33, v33, s44, v100
    v_mul_f32 v33, s45, v33
    v_exp_f32 v33, v33
    s_nop 0
    v_add_f32 v33, 1.0, v33
    v_rcp_f32 v33, v33
    s_nop 0
    v_mul_f32 v100, v100, v33
    v_cvt_pk_bf16_f32 v101, v101, v101
    v_lshlrev_b32 v101, 16, v101
    v_and_b32 v32, 0xffff0000, v26
    v_add_f32 v101, v101, v32
    v_cvt_pk_bf16_f32 v101, v101, v101
    v_lshlrev_b32 v101, 16, v101
    v_mul_f32 v33, v101, v101
    v_mul_f32 v33, v33, v101
    v_fma_f32 v33, v33, s44, v101
    v_mul_f32 v33, s45, v33
    v_exp_f32 v33, v33
    s_nop 0
    v_add_f32 v33, 1.0, v33
    v_rcp_f32 v33, v33
    s_nop 0
    v_mul_f32 v101, v101, v33
    v_cvt_pk_bf16_f32 v102, v102, v102
    v_lshlrev_b32 v102, 16, v102
    v_lshlrev_b32 v32, 16, v27
    v_add_f32 v102, v102, v32
    v_cvt_pk_bf16_f32 v102, v102, v102
    v_lshlrev_b32 v102, 16, v102
    v_mul_f32 v33, v102, v102
    v_mul_f32 v33, v33, v102
    v_fma_f32 v33, v33, s44, v102
    v_mul_f32 v33, s45, v33
    v_exp_f32 v33, v33
    s_nop 0
    v_add_f32 v33, 1.0, v33
    v_rcp_f32 v33, v33
    s_nop 0
    v_mul_f32 v102, v102, v33
    v_cvt_pk_bf16_f32 v103, v103, v103
    v_lshlrev_b32 v103, 16, v103
    v_and_b32 v32, 0xffff0000, v27
    v_add_f32 v103, v103, v32
    v_cvt_pk_bf16_f32 v103, v103, v103
    v_lshlrev_b32 v103, 16, v103
    v_mul_f32 v33, v103, v103
    v_mul_f32 v33, v33, v103
    v_fma_f32 v33, v33, s44, v103
    v_mul_f32 v33, s45, v33
    v_exp_f32 v33, v33
    s_nop 0
    v_add_f32 v33, 1.0, v33
    v_rcp_f32 v33, v33
    s_nop 0
    v_mul_f32 v103, v103, v33
    v_cvt_pk_bf16_f32 v36, v100, v101
    v_cvt_pk_bf16_f32 v37, v102, v103
    buffer_store_dwordx2 v[36:37], v12, s[8:11], s36 offen offset:80 sc1
    s_nop 1
    v_cvt_pk_bf16_f32 v104, v104, v104
    v_lshlrev_b32 v104, 16, v104
    v_lshlrev_b32 v32, 16, v28
    v_add_f32 v104, v104, v32
    v_cvt_pk_bf16_f32 v104, v104, v104
    v_lshlrev_b32 v104, 16, v104
    v_mul_f32 v33, v104, v104
    v_mul_f32 v33, v33, v104
    v_fma_f32 v33, v33, s44, v104
    v_mul_f32 v33, s45, v33
    v_exp_f32 v33, v33
    s_nop 0
    v_add_f32 v33, 1.0, v33
    v_rcp_f32 v33, v33
    s_nop 0
    v_mul_f32 v104, v104, v33
    v_cvt_pk_bf16_f32 v105, v105, v105
    v_lshlrev_b32 v105, 16, v105
    v_and_b32 v32, 0xffff0000, v28
    v_add_f32 v105, v105, v32
    v_cvt_pk_bf16_f32 v105, v105, v105
    v_lshlrev_b32 v105, 16, v105
    v_mul_f32 v33, v105, v105
    v_mul_f32 v33, v33, v105
    v_fma_f32 v33, v33, s44, v105
    v_mul_f32 v33, s45, v33
    v_exp_f32 v33, v33
    s_nop 0
    v_add_f32 v33, 1.0, v33
    v_rcp_f32 v33, v33
    s_nop 0
    v_mul_f32 v105, v105, v33
    v_cvt_pk_bf16_f32 v106, v106, v106
    v_lshlrev_b32 v106, 16, v106
    v_lshlrev_b32 v32, 16, v29
    v_add_f32 v106, v106, v32
    v_cvt_pk_bf16_f32 v106, v106, v106
    v_lshlrev_b32 v106, 16, v106
    v_mul_f32 v33, v106, v106
    v_mul_f32 v33, v33, v106
    v_fma_f32 v33, v33, s44, v106
    v_mul_f32 v33, s45, v33
    v_exp_f32 v33, v33
    s_nop 0
    v_add_f32 v33, 1.0, v33
    v_rcp_f32 v33, v33
    s_nop 0
    v_mul_f32 v106, v106, v33
    v_cvt_pk_bf16_f32 v107, v107, v107
    v_lshlrev_b32 v107, 16, v107
    v_and_b32 v32, 0xffff0000, v29
    v_add_f32 v107, v107, v32
    v_cvt_pk_bf16_f32 v107, v107, v107
    v_lshlrev_b32 v107, 16, v107
    v_mul_f32 v33, v107, v107
    v_mul_f32 v33, v33, v107
    v_fma_f32 v33, v33, s44, v107
    v_mul_f32 v33, s45, v33
    v_exp_f32 v33, v33
    s_nop 0
    v_add_f32 v33, 1.0, v33
    v_rcp_f32 v33, v33
    s_nop 0
    v_mul_f32 v107, v107, v33
    v_cvt_pk_bf16_f32 v36, v104, v105
    v_cvt_pk_bf16_f32 v37, v106, v107
    buffer_store_dwordx2 v[36:37], v12, s[8:11], s36 offen offset:96 sc1
    s_nop 1
    v_cvt_pk_bf16_f32 v108, v108, v108
    v_lshlrev_b32 v108, 16, v108
    v_lshlrev_b32 v32, 16, v30
    v_add_f32 v108, v108, v32
    v_cvt_pk_bf16_f32 v108, v108, v108
    v_lshlrev_b32 v108, 16, v108
    v_mul_f32 v33, v108, v108
    v_mul_f32 v33, v33, v108
    v_fma_f32 v33, v33, s44, v108
    v_mul_f32 v33, s45, v33
    v_exp_f32 v33, v33
    s_nop 0
    v_add_f32 v33, 1.0, v33
    v_rcp_f32 v33, v33
    s_nop 0
    v_mul_f32 v108, v108, v33
    v_cvt_pk_bf16_f32 v109, v109, v109
    v_lshlrev_b32 v109, 16, v109
    v_and_b32 v32, 0xffff0000, v30
    v_add_f32 v109, v109, v32
    v_cvt_pk_bf16_f32 v109, v109, v109
    v_lshlrev_b32 v109, 16, v109
    v_mul_f32 v33, v109, v109
    v_mul_f32 v33, v33, v109
    v_fma_f32 v33, v33, s44, v109
    v_mul_f32 v33, s45, v33
    v_exp_f32 v33, v33
    s_nop 0
    v_add_f32 v33, 1.0, v33
    v_rcp_f32 v33, v33
    s_nop 0
    v_mul_f32 v109, v109, v33
    v_cvt_pk_bf16_f32 v110, v110, v110
    v_lshlrev_b32 v110, 16, v110
    v_lshlrev_b32 v32, 16, v31
    v_add_f32 v110, v110, v32
    v_cvt_pk_bf16_f32 v110, v110, v110
    v_lshlrev_b32 v110, 16, v110
    v_mul_f32 v33, v110, v110
    v_mul_f32 v33, v33, v110
    v_fma_f32 v33, v33, s44, v110
    v_mul_f32 v33, s45, v33
    v_exp_f32 v33, v33
    s_nop 0
    v_add_f32 v33, 1.0, v33
    v_rcp_f32 v33, v33
    s_nop 0
    v_mul_f32 v110, v110, v33
    v_cvt_pk_bf16_f32 v111, v111, v111
    v_lshlrev_b32 v111, 16, v111
    v_and_b32 v32, 0xffff0000, v31
    v_add_f32 v111, v111, v32
    v_cvt_pk_bf16_f32 v111, v111, v111
    v_lshlrev_b32 v111, 16, v111
    v_mul_f32 v33, v111, v111
    v_mul_f32 v33, v33, v111
    v_fma_f32 v33, v33, s44, v111
    v_mul_f32 v33, s45, v33
    v_exp_f32 v33, v33
    s_nop 0
    v_add_f32 v33, 1.0, v33
    v_rcp_f32 v33, v33
    s_nop 0
    v_mul_f32 v111, v111, v33
    v_cvt_pk_bf16_f32 v36, v108, v109
    v_cvt_pk_bf16_f32 v37, v110, v111
    buffer_store_dwordx2 v[36:37], v12, s[8:11], s36 offen offset:112 sc1
    s_nop 1
    v_cvt_pk_bf16_f32 v112, v112, v112
    v_lshlrev_b32 v112, 16, v112
    v_lshlrev_b32 v32, 16, v16
    v_add_f32 v112, v112, v32
    v_cvt_pk_bf16_f32 v112, v112, v112
    v_lshlrev_b32 v112, 16, v112
    v_mul_f32 v33, v112, v112
    v_mul_f32 v33, v33, v112
    v_fma_f32 v33, v33, s44, v112
    v_mul_f32 v33, s45, v33
    v_exp_f32 v33, v33
    s_nop 0
    v_add_f32 v33, 1.0, v33
    v_rcp_f32 v33, v33
    s_nop 0
    v_mul_f32 v112, v112, v33
    v_cvt_pk_bf16_f32 v113, v113, v113
    v_lshlrev_b32 v113, 16, v113
    v_and_b32 v32, 0xffff0000, v16
    v_add_f32 v113, v113, v32
    v_cvt_pk_bf16_f32 v113, v113, v113
    v_lshlrev_b32 v113, 16, v113
    v_mul_f32 v33, v113, v113
    v_mul_f32 v33, v33, v113
    v_fma_f32 v33, v33, s44, v113
    v_mul_f32 v33, s45, v33
    v_exp_f32 v33, v33
    s_nop 0
    v_add_f32 v33, 1.0, v33
    v_rcp_f32 v33, v33
    s_nop 0
    v_mul_f32 v113, v113, v33
    v_cvt_pk_bf16_f32 v114, v114, v114
    v_lshlrev_b32 v114, 16, v114
    v_lshlrev_b32 v32, 16, v17
    v_add_f32 v114, v114, v32
    v_cvt_pk_bf16_f32 v114, v114, v114
    v_lshlrev_b32 v114, 16, v114
    v_mul_f32 v33, v114, v114
    v_mul_f32 v33, v33, v114
    v_fma_f32 v33, v33, s44, v114
    v_mul_f32 v33, s45, v33
    v_exp_f32 v33, v33
    s_nop 0
    v_add_f32 v33, 1.0, v33
    v_rcp_f32 v33, v33
    s_nop 0
    v_mul_f32 v114, v114, v33
    v_cvt_pk_bf16_f32 v115, v115, v115
    v_lshlrev_b32 v115, 16, v115
    v_and_b32 v32, 0xffff0000, v17
    v_add_f32 v115, v115, v32
    v_cvt_pk_bf16_f32 v115, v115, v115
    v_lshlrev_b32 v115, 16, v115
    v_mul_f32 v33, v115, v115
    v_mul_f32 v33, v33, v115
    v_fma_f32 v33, v33, s44, v115
    v_mul_f32 v33, s45, v33
    v_exp_f32 v33, v33
    s_nop 0
    v_add_f32 v33, 1.0, v33
    v_rcp_f32 v33, v33
    s_nop 0
    v_mul_f32 v115, v115, v33
    v_cvt_pk_bf16_f32 v36, v112, v113
    v_cvt_pk_bf16_f32 v37, v114, v115
    buffer_store_dwordx2 v[36:37], v13, s[8:11], s36 offen offset:0 sc1
    s_nop 1
    v_cvt_pk_bf16_f32 v116, v116, v116
    v_lshlrev_b32 v116, 16, v116
    v_lshlrev_b32 v32, 16, v18
    v_add_f32 v116, v116, v32
    v_cvt_pk_bf16_f32 v116, v116, v116
    v_lshlrev_b32 v116, 16, v116
    v_mul_f32 v33, v116, v116
    v_mul_f32 v33, v33, v116
    v_fma_f32 v33, v33, s44, v116
    v_mul_f32 v33, s45, v33
    v_exp_f32 v33, v33
    s_nop 0
    v_add_f32 v33, 1.0, v33
    v_rcp_f32 v33, v33
    s_nop 0
    v_mul_f32 v116, v116, v33
    v_cvt_pk_bf16_f32 v117, v117, v117
    v_lshlrev_b32 v117, 16, v117
    v_and_b32 v32, 0xffff0000, v18
    v_add_f32 v117, v117, v32
    v_cvt_pk_bf16_f32 v117, v117, v117
    v_lshlrev_b32 v117, 16, v117
    v_mul_f32 v33, v117, v117
    v_mul_f32 v33, v33, v117
    v_fma_f32 v33, v33, s44, v117
    v_mul_f32 v33, s45, v33
    v_exp_f32 v33, v33
    s_nop 0
    v_add_f32 v33, 1.0, v33
    v_rcp_f32 v33, v33
    s_nop 0
    v_mul_f32 v117, v117, v33
    v_cvt_pk_bf16_f32 v118, v118, v118
    v_lshlrev_b32 v118, 16, v118
    v_lshlrev_b32 v32, 16, v19
    v_add_f32 v118, v118, v32
    v_cvt_pk_bf16_f32 v118, v118, v118
    v_lshlrev_b32 v118, 16, v118
    v_mul_f32 v33, v118, v118
    v_mul_f32 v33, v33, v118
    v_fma_f32 v33, v33, s44, v118
    v_mul_f32 v33, s45, v33
    v_exp_f32 v33, v33
    s_nop 0
    v_add_f32 v33, 1.0, v33
    v_rcp_f32 v33, v33
    s_nop 0
    v_mul_f32 v118, v118, v33
    v_cvt_pk_bf16_f32 v119, v119, v119
    v_lshlrev_b32 v119, 16, v119
    v_and_b32 v32, 0xffff0000, v19
    v_add_f32 v119, v119, v32
    v_cvt_pk_bf16_f32 v119, v119, v119
    v_lshlrev_b32 v119, 16, v119
    v_mul_f32 v33, v119, v119
    v_mul_f32 v33, v33, v119
    v_fma_f32 v33, v33, s44, v119
    v_mul_f32 v33, s45, v33
    v_exp_f32 v33, v33
    s_nop 0
    v_add_f32 v33, 1.0, v33
    v_rcp_f32 v33, v33
    s_nop 0
    v_mul_f32 v119, v119, v33
    v_cvt_pk_bf16_f32 v36, v116, v117
    v_cvt_pk_bf16_f32 v37, v118, v119
    buffer_store_dwordx2 v[36:37], v13, s[8:11], s36 offen offset:16 sc1
    s_nop 1
    v_cvt_pk_bf16_f32 v120, v120, v120
    v_lshlrev_b32 v120, 16, v120
    v_lshlrev_b32 v32, 16, v20
    v_add_f32 v120, v120, v32
    v_cvt_pk_bf16_f32 v120, v120, v120
    v_lshlrev_b32 v120, 16, v120
    v_mul_f32 v33, v120, v120
    v_mul_f32 v33, v33, v120
    v_fma_f32 v33, v33, s44, v120
    v_mul_f32 v33, s45, v33
    v_exp_f32 v33, v33
    s_nop 0
    v_add_f32 v33, 1.0, v33
    v_rcp_f32 v33, v33
    s_nop 0
    v_mul_f32 v120, v120, v33
    v_cvt_pk_bf16_f32 v121, v121, v121
    v_lshlrev_b32 v121, 16, v121
    v_and_b32 v32, 0xffff0000, v20
    v_add_f32 v121, v121, v32
    v_cvt_pk_bf16_f32 v121, v121, v121
    v_lshlrev_b32 v121, 16, v121
    v_mul_f32 v33, v121, v121
    v_mul_f32 v33, v33, v121
    v_fma_f32 v33, v33, s44, v121
    v_mul_f32 v33, s45, v33
    v_exp_f32 v33, v33
    s_nop 0
    v_add_f32 v33, 1.0, v33
    v_rcp_f32 v33, v33
    s_nop 0
    v_mul_f32 v121, v121, v33
    v_cvt_pk_bf16_f32 v122, v122, v122
    v_lshlrev_b32 v122, 16, v122
    v_lshlrev_b32 v32, 16, v21
    v_add_f32 v122, v122, v32
    v_cvt_pk_bf16_f32 v122, v122, v122
    v_lshlrev_b32 v122, 16, v122
    v_mul_f32 v33, v122, v122
    v_mul_f32 v33, v33, v122
    v_fma_f32 v33, v33, s44, v122
    v_mul_f32 v33, s45, v33
    v_exp_f32 v33, v33
    s_nop 0
    v_add_f32 v33, 1.0, v33
    v_rcp_f32 v33, v33
    s_nop 0
    v_mul_f32 v122, v122, v33
    v_cvt_pk_bf16_f32 v123, v123, v123
    v_lshlrev_b32 v123, 16, v123
    v_and_b32 v32, 0xffff0000, v21
    v_add_f32 v123, v123, v32
    v_cvt_pk_bf16_f32 v123, v123, v123
    v_lshlrev_b32 v123, 16, v123
    v_mul_f32 v33, v123, v123
    v_mul_f32 v33, v33, v123
    v_fma_f32 v33, v33, s44, v123
    v_mul_f32 v33, s45, v33
    v_exp_f32 v33, v33
    s_nop 0
    v_add_f32 v33, 1.0, v33
    v_rcp_f32 v33, v33
    s_nop 0
    v_mul_f32 v123, v123, v33
    v_cvt_pk_bf16_f32 v36, v120, v121
    v_cvt_pk_bf16_f32 v37, v122, v123
    buffer_store_dwordx2 v[36:37], v13, s[8:11], s36 offen offset:32 sc1
    s_nop 1
    v_cvt_pk_bf16_f32 v124, v124, v124
    v_lshlrev_b32 v124, 16, v124
    v_lshlrev_b32 v32, 16, v22
    v_add_f32 v124, v124, v32
    v_cvt_pk_bf16_f32 v124, v124, v124
    v_lshlrev_b32 v124, 16, v124
    v_mul_f32 v33, v124, v124
    v_mul_f32 v33, v33, v124
    v_fma_f32 v33, v33, s44, v124
    v_mul_f32 v33, s45, v33
    v_exp_f32 v33, v33
    s_nop 0
    v_add_f32 v33, 1.0, v33
    v_rcp_f32 v33, v33
    s_nop 0
    v_mul_f32 v124, v124, v33
    v_cvt_pk_bf16_f32 v125, v125, v125
    v_lshlrev_b32 v125, 16, v125
    v_and_b32 v32, 0xffff0000, v22
    v_add_f32 v125, v125, v32
    v_cvt_pk_bf16_f32 v125, v125, v125
    v_lshlrev_b32 v125, 16, v125
    v_mul_f32 v33, v125, v125
    v_mul_f32 v33, v33, v125
    v_fma_f32 v33, v33, s44, v125
    v_mul_f32 v33, s45, v33
    v_exp_f32 v33, v33
    s_nop 0
    v_add_f32 v33, 1.0, v33
    v_rcp_f32 v33, v33
    s_nop 0
    v_mul_f32 v125, v125, v33
    v_cvt_pk_bf16_f32 v126, v126, v126
    v_lshlrev_b32 v126, 16, v126
    v_lshlrev_b32 v32, 16, v23
    v_add_f32 v126, v126, v32
    v_cvt_pk_bf16_f32 v126, v126, v126
    v_lshlrev_b32 v126, 16, v126
    v_mul_f32 v33, v126, v126
    v_mul_f32 v33, v33, v126
    v_fma_f32 v33, v33, s44, v126
    v_mul_f32 v33, s45, v33
    v_exp_f32 v33, v33
    s_nop 0
    v_add_f32 v33, 1.0, v33
    v_rcp_f32 v33, v33
    s_nop 0
    v_mul_f32 v126, v126, v33
    v_cvt_pk_bf16_f32 v127, v127, v127
    v_lshlrev_b32 v127, 16, v127
    v_and_b32 v32, 0xffff0000, v23
    v_add_f32 v127, v127, v32
    v_cvt_pk_bf16_f32 v127, v127, v127
    v_lshlrev_b32 v127, 16, v127
    v_mul_f32 v33, v127, v127
    v_mul_f32 v33, v33, v127
    v_fma_f32 v33, v33, s44, v127
    v_mul_f32 v33, s45, v33
    v_exp_f32 v33, v33
    s_nop 0
    v_add_f32 v33, 1.0, v33
    v_rcp_f32 v33, v33
    s_nop 0
    v_mul_f32 v127, v127, v33
    v_cvt_pk_bf16_f32 v36, v124, v125
    v_cvt_pk_bf16_f32 v37, v126, v127
    buffer_store_dwordx2 v[36:37], v13, s[8:11], s36 offen offset:48 sc1
    s_nop 1
    v_cvt_pk_bf16_f32 v128, v128, v128
    v_lshlrev_b32 v128, 16, v128
    v_lshlrev_b32 v32, 16, v24
    v_add_f32 v128, v128, v32
    v_cvt_pk_bf16_f32 v128, v128, v128
    v_lshlrev_b32 v128, 16, v128
    v_mul_f32 v33, v128, v128
    v_mul_f32 v33, v33, v128
    v_fma_f32 v33, v33, s44, v128
    v_mul_f32 v33, s45, v33
    v_exp_f32 v33, v33
    s_nop 0
    v_add_f32 v33, 1.0, v33
    v_rcp_f32 v33, v33
    s_nop 0
    v_mul_f32 v128, v128, v33
    v_cvt_pk_bf16_f32 v129, v129, v129
    v_lshlrev_b32 v129, 16, v129
    v_and_b32 v32, 0xffff0000, v24
    v_add_f32 v129, v129, v32
    v_cvt_pk_bf16_f32 v129, v129, v129
    v_lshlrev_b32 v129, 16, v129
    v_mul_f32 v33, v129, v129
    v_mul_f32 v33, v33, v129
    v_fma_f32 v33, v33, s44, v129
    v_mul_f32 v33, s45, v33
    v_exp_f32 v33, v33
    s_nop 0
    v_add_f32 v33, 1.0, v33
    v_rcp_f32 v33, v33
    s_nop 0
    v_mul_f32 v129, v129, v33
    v_cvt_pk_bf16_f32 v130, v130, v130
    v_lshlrev_b32 v130, 16, v130
    v_lshlrev_b32 v32, 16, v25
    v_add_f32 v130, v130, v32
    v_cvt_pk_bf16_f32 v130, v130, v130
    v_lshlrev_b32 v130, 16, v130
    v_mul_f32 v33, v130, v130
    v_mul_f32 v33, v33, v130
    v_fma_f32 v33, v33, s44, v130
    v_mul_f32 v33, s45, v33
    v_exp_f32 v33, v33
    s_nop 0
    v_add_f32 v33, 1.0, v33
    v_rcp_f32 v33, v33
    s_nop 0
    v_mul_f32 v130, v130, v33
    v_cvt_pk_bf16_f32 v131, v131, v131
    v_lshlrev_b32 v131, 16, v131
    v_and_b32 v32, 0xffff0000, v25
    v_add_f32 v131, v131, v32
    v_cvt_pk_bf16_f32 v131, v131, v131
    v_lshlrev_b32 v131, 16, v131
    v_mul_f32 v33, v131, v131
    v_mul_f32 v33, v33, v131
    v_fma_f32 v33, v33, s44, v131
    v_mul_f32 v33, s45, v33
    v_exp_f32 v33, v33
    s_nop 0
    v_add_f32 v33, 1.0, v33
    v_rcp_f32 v33, v33
    s_nop 0
    v_mul_f32 v131, v131, v33
    v_cvt_pk_bf16_f32 v36, v128, v129
    v_cvt_pk_bf16_f32 v37, v130, v131
    buffer_store_dwordx2 v[36:37], v13, s[8:11], s36 offen offset:64 sc1
    s_nop 1
    v_cvt_pk_bf16_f32 v132, v132, v132
    v_lshlrev_b32 v132, 16, v132
    v_lshlrev_b32 v32, 16, v26
    v_add_f32 v132, v132, v32
    v_cvt_pk_bf16_f32 v132, v132, v132
    v_lshlrev_b32 v132, 16, v132
    v_mul_f32 v33, v132, v132
    v_mul_f32 v33, v33, v132
    v_fma_f32 v33, v33, s44, v132
    v_mul_f32 v33, s45, v33
    v_exp_f32 v33, v33
    s_nop 0
    v_add_f32 v33, 1.0, v33
    v_rcp_f32 v33, v33
    s_nop 0
    v_mul_f32 v132, v132, v33
    v_cvt_pk_bf16_f32 v133, v133, v133
    v_lshlrev_b32 v133, 16, v133
    v_and_b32 v32, 0xffff0000, v26
    v_add_f32 v133, v133, v32
    v_cvt_pk_bf16_f32 v133, v133, v133
    v_lshlrev_b32 v133, 16, v133
    v_mul_f32 v33, v133, v133
    v_mul_f32 v33, v33, v133
    v_fma_f32 v33, v33, s44, v133
    v_mul_f32 v33, s45, v33
    v_exp_f32 v33, v33
    s_nop 0
    v_add_f32 v33, 1.0, v33
    v_rcp_f32 v33, v33
    s_nop 0
    v_mul_f32 v133, v133, v33
    v_cvt_pk_bf16_f32 v134, v134, v134
    v_lshlrev_b32 v134, 16, v134
    v_lshlrev_b32 v32, 16, v27
    v_add_f32 v134, v134, v32
    v_cvt_pk_bf16_f32 v134, v134, v134
    v_lshlrev_b32 v134, 16, v134
    v_mul_f32 v33, v134, v134
    v_mul_f32 v33, v33, v134
    v_fma_f32 v33, v33, s44, v134
    v_mul_f32 v33, s45, v33
    v_exp_f32 v33, v33
    s_nop 0
    v_add_f32 v33, 1.0, v33
    v_rcp_f32 v33, v33
    s_nop 0
    v_mul_f32 v134, v134, v33
    v_cvt_pk_bf16_f32 v135, v135, v135
    v_lshlrev_b32 v135, 16, v135
    v_and_b32 v32, 0xffff0000, v27
    v_add_f32 v135, v135, v32
    v_cvt_pk_bf16_f32 v135, v135, v135
    v_lshlrev_b32 v135, 16, v135
    v_mul_f32 v33, v135, v135
    v_mul_f32 v33, v33, v135
    v_fma_f32 v33, v33, s44, v135
    v_mul_f32 v33, s45, v33
    v_exp_f32 v33, v33
    s_nop 0
    v_add_f32 v33, 1.0, v33
    v_rcp_f32 v33, v33
    s_nop 0
    v_mul_f32 v135, v135, v33
    v_cvt_pk_bf16_f32 v36, v132, v133
    v_cvt_pk_bf16_f32 v37, v134, v135
    buffer_store_dwordx2 v[36:37], v13, s[8:11], s36 offen offset:80 sc1
    s_nop 1
    v_cvt_pk_bf16_f32 v136, v136, v136
    v_lshlrev_b32 v136, 16, v136
    v_lshlrev_b32 v32, 16, v28
    v_add_f32 v136, v136, v32
    v_cvt_pk_bf16_f32 v136, v136, v136
    v_lshlrev_b32 v136, 16, v136
    v_mul_f32 v33, v136, v136
    v_mul_f32 v33, v33, v136
    v_fma_f32 v33, v33, s44, v136
    v_mul_f32 v33, s45, v33
    v_exp_f32 v33, v33
    s_nop 0
    v_add_f32 v33, 1.0, v33
    v_rcp_f32 v33, v33
    s_nop 0
    v_mul_f32 v136, v136, v33
    v_cvt_pk_bf16_f32 v137, v137, v137
    v_lshlrev_b32 v137, 16, v137
    v_and_b32 v32, 0xffff0000, v28
    v_add_f32 v137, v137, v32
    v_cvt_pk_bf16_f32 v137, v137, v137
    v_lshlrev_b32 v137, 16, v137
    v_mul_f32 v33, v137, v137
    v_mul_f32 v33, v33, v137
    v_fma_f32 v33, v33, s44, v137
    v_mul_f32 v33, s45, v33
    v_exp_f32 v33, v33
    s_nop 0
    v_add_f32 v33, 1.0, v33
    v_rcp_f32 v33, v33
    s_nop 0
    v_mul_f32 v137, v137, v33
    v_cvt_pk_bf16_f32 v138, v138, v138
    v_lshlrev_b32 v138, 16, v138
    v_lshlrev_b32 v32, 16, v29
    v_add_f32 v138, v138, v32
    v_cvt_pk_bf16_f32 v138, v138, v138
    v_lshlrev_b32 v138, 16, v138
    v_mul_f32 v33, v138, v138
    v_mul_f32 v33, v33, v138
    v_fma_f32 v33, v33, s44, v138
    v_mul_f32 v33, s45, v33
    v_exp_f32 v33, v33
    s_nop 0
    v_add_f32 v33, 1.0, v33
    v_rcp_f32 v33, v33
    s_nop 0
    v_mul_f32 v138, v138, v33
    v_cvt_pk_bf16_f32 v139, v139, v139
    v_lshlrev_b32 v139, 16, v139
    v_and_b32 v32, 0xffff0000, v29
    v_add_f32 v139, v139, v32
    v_cvt_pk_bf16_f32 v139, v139, v139
    v_lshlrev_b32 v139, 16, v139
    v_mul_f32 v33, v139, v139
    v_mul_f32 v33, v33, v139
    v_fma_f32 v33, v33, s44, v139
    v_mul_f32 v33, s45, v33
    v_exp_f32 v33, v33
    s_nop 0
    v_add_f32 v33, 1.0, v33
    v_rcp_f32 v33, v33
    s_nop 0
    v_mul_f32 v139, v139, v33
    v_cvt_pk_bf16_f32 v36, v136, v137
    v_cvt_pk_bf16_f32 v37, v138, v139
    buffer_store_dwordx2 v[36:37], v13, s[8:11], s36 offen offset:96 sc1
    s_nop 1
    v_cvt_pk_bf16_f32 v140, v140, v140
    v_lshlrev_b32 v140, 16, v140
    v_lshlrev_b32 v32, 16, v30
    v_add_f32 v140, v140, v32
    v_cvt_pk_bf16_f32 v140, v140, v140
    v_lshlrev_b32 v140, 16, v140
    v_mul_f32 v33, v140, v140
    v_mul_f32 v33, v33, v140
    v_fma_f32 v33, v33, s44, v140
    v_mul_f32 v33, s45, v33
    v_exp_f32 v33, v33
    s_nop 0
    v_add_f32 v33, 1.0, v33
    v_rcp_f32 v33, v33
    s_nop 0
    v_mul_f32 v140, v140, v33
    v_cvt_pk_bf16_f32 v141, v141, v141
    v_lshlrev_b32 v141, 16, v141
    v_and_b32 v32, 0xffff0000, v30
    v_add_f32 v141, v141, v32
    v_cvt_pk_bf16_f32 v141, v141, v141
    v_lshlrev_b32 v141, 16, v141
    v_mul_f32 v33, v141, v141
    v_mul_f32 v33, v33, v141
    v_fma_f32 v33, v33, s44, v141
    v_mul_f32 v33, s45, v33
    v_exp_f32 v33, v33
    s_nop 0
    v_add_f32 v33, 1.0, v33
    v_rcp_f32 v33, v33
    s_nop 0
    v_mul_f32 v141, v141, v33
    v_cvt_pk_bf16_f32 v142, v142, v142
    v_lshlrev_b32 v142, 16, v142
    v_lshlrev_b32 v32, 16, v31
    v_add_f32 v142, v142, v32
    v_cvt_pk_bf16_f32 v142, v142, v142
    v_lshlrev_b32 v142, 16, v142
    v_mul_f32 v33, v142, v142
    v_mul_f32 v33, v33, v142
    v_fma_f32 v33, v33, s44, v142
    v_mul_f32 v33, s45, v33
    v_exp_f32 v33, v33
    s_nop 0
    v_add_f32 v33, 1.0, v33
    v_rcp_f32 v33, v33
    s_nop 0
    v_mul_f32 v142, v142, v33
    v_cvt_pk_bf16_f32 v143, v143, v143
    v_lshlrev_b32 v143, 16, v143
    v_and_b32 v32, 0xffff0000, v31
    v_add_f32 v143, v143, v32
    v_cvt_pk_bf16_f32 v143, v143, v143
    v_lshlrev_b32 v143, 16, v143
    v_mul_f32 v33, v143, v143
    v_mul_f32 v33, v33, v143
    v_fma_f32 v33, v33, s44, v143
    v_mul_f32 v33, s45, v33
    v_exp_f32 v33, v33
    s_nop 0
    v_add_f32 v33, 1.0, v33
    v_rcp_f32 v33, v33
    s_nop 0
    v_mul_f32 v143, v143, v33
    v_cvt_pk_bf16_f32 v36, v140, v141
    v_cvt_pk_bf16_f32 v37, v142, v143
    buffer_store_dwordx2 v[36:37], v13, s[8:11], s36 offen offset:112 sc1
    s_nop 1
    s_branch wk_done
wk_done:
    s_lshl_b32 s7, s3, 2
    s_add_u32 s6, s7, 64
    s_add_u32 s7, s7, 128
    s_cmp_lt_u32 s61, 448
    s_cselect_b32 s7, s6, s7
    s_waitcnt vmcnt(0)
    s_barrier
    v_mov_b32 v1, 1
    s_add_u32 s5, s7, 117440512
    v_mov_b32 v2, s5
    v_cmp_eq_u32 vcc, 0, v0
    s_and_saveexec_b64 s[46:47], vcc
    buffer_atomic_add v1, v2, s[8:11], 0 offen sc1
    s_mov_b64 exec, s[46:47]
    s_barrier
    s_add_u32 s61, s61, 256
    s_branch wk_loop
wk_mlp2:
    s_cmp_ge_u32 s60, 128
    s_cbranch_scc1 wk_attn
    s_and_b32 s3, s60, 15
    s_lshr_b32 s4, s60, 4
    s_mov_b32 s8, s28
    s_mov_b32 s9, s29
    s_mov_b32 s10, 268435456
    s_mov_b32 s11, 0x00020000
    s_lshl_b32 s7, s3, 2
    s_add_u32 s7, s7, 64
    s_add_u32 s5, s7, 117440512
    v_mov_b32 v2, s5
    s_mov_b32 s6, 0
    v_lshrrev_b32 v1, 6, v0
    s_nop 1
    v_readfirstlane_b32 s75, v1
    s_nop 3
    s_cmp_lg_u32 s75, 0
    s_cbranch_scc1 wk_g_5
wk_w_4:
    buffer_load_dword v1, v2, s[8:11], 0 offen sc1
    s_waitcnt vmcnt(0)
    v_cmp_le_u32 vcc, 28, v1
    s_cbranch_vccnz wk_g_5
    s_sleep 48
    s_add_u32 s6, s6, 1
    s_cmp_lt_u32 s6, 0x80000
    s_cbranch_scc1 wk_w_4
wk_g_5:
    s_barrier
    s_barrier
    s_mov_b32 s40, 18432
    s_mov_b32 s12, s64
    s_mov_b32 s13, s65
    s_mov_b32 s14, 7340032
    s_mov_b32 s15, 0x00020000
    v_and_b32 v6, 63, v0
    v_lshrrev_b32 v7, 6, v0
    v_lshrrev_b32 v1, 3, v0
    v_mul_u32_u24 v2, 144, v1
    v_and_b32 v1, 7, v0
    v_lshlrev_b32 v1, 4, v1
    v_add_u32 v2, v2, v1
    v_lshrrev_b32 v1, 4, v0
    v_mul_u32_u24 v3, 320, v1
    v_and_b32 v1, 15, v0
    v_lshlrev_b32 v1, 4, v1
    v_add3_u32 v3, v3, v1, s40
    v_lshrrev_b32 v1, 1, v7
    v_lshlrev_b32 v1, 6, v1
    v_and_b32 v8, 31, v6
    v_add_u32 v1, v1, v8
    v_mul_u32_u24 v4, 144, v1
    v_lshrrev_b32 v1, 5, v6
    v_lshlrev_b32 v1, 4, v1
    v_add_u32 v4, v4, v1
    v_lshrrev_b32 v1, 5, v6
    v_lshlrev_b32 v1, 3, v1
    v_and_b32 v8, 15, v6
    v_lshrrev_b32 v8, 2, v8
    v_add_u32 v1, v1, v8
    v_mul_u32_u24 v5, 320, v1
    v_and_b32 v1, 1, v7
    v_lshlrev_b32 v1, 7, v1
    v_bfe_u32 v8, v6, 4, 1
    v_lshlrev_b32 v8, 5, v8
    v_add_u32 v1, v1, v8
    v_and_b32 v8, 3, v6
    v_lshlrev_b32 v8, 3, v8
    v_add3_u32 v5, v5, v1, v8
    v_add_u32 v5, s40, v5
    v_add_u32 v2, s57, v2
    v_add_u32 v3, s57, v3
    v_add_u32 v4, s57, v4
    v_add_u32 v5, s57, v5
    v_lshrrev_b32 v1, 3, v0
    s_lshl_b32 s34, s3, 7
    v_add_u32 v1, s34, v1
    s_mov_b32 s34, 7168
    v_mul_lo_u32 v10, v1, s34
    v_and_b32 v1, 7, v0
    v_lshlrev_b32 v1, 4, v1
    v_add_u32 v10, v10, v1
    v_lshrrev_b32 v1, 4, v0
    v_lshlrev_b32 v11, 11, v1
    v_and_b32 v1, 15, v0
    v_lshlrev_b32 v1, 4, v1
    s_lshl_b32 s34, s4, 8
    v_add3_u32 v11, v11, v1, s34
    s_mov_b32 s48, 58720256
    s_mov_b32 s52, 0
    s_mov_b32 s49, 58949632
    s_mov_b32 s53, 32768
    s_mov_b32 s50, 59179008
    s_mov_b32 s54, 65536
    s_mov_b32 s51, 59408384
    s_mov_b32 s55, 98304
    s_mov_b32 s35, 131072
    v_mov_b32 v80, 0
    v_mov_b32 v81, 0
    v_mov_b32 v82, 0
    v_mov_b32 v83, 0
    v_mov_b32 v84, 0
    v_mov_b32 v85, 0
    v_mov_b32 v86, 0
    v_mov_b32 v87, 0
    v_mov_b32 v88, 0
    v_mov_b32 v89, 0
    v_mov_b32 v90, 0
    v_mov_b32 v91, 0
    v_mov_b32 v92, 0
    v_mov_b32 v93, 0
    v_mov_b32 v94, 0
    v_mov_b32 v95, 0
    v_mov_b32 v96, 0
    v_mov_b32 v97, 0
    v_mov_b32 v98, 0
    v_mov_b32 v99, 0
    v_mov_b32 v100, 0
    v_mov_b32 v101, 0
    v_mov_b32 v102, 0
    v_mov_b32 v103, 0
    v_mov_b32 v104, 0
    v_mov_b32 v105, 0
    v_mov_b32 v106, 0
    v_mov_b32 v107, 0
    v_mov_b32 v108, 0
    v_mov_b32 v109, 0
    v_mov_b32 v110, 0
    v_mov_b32 v111, 0
    v_mov_b32 v112, 0
    v_mov_b32 v113, 0
    v_mov_b32 v114, 0
    v_mov_b32 v115, 0
    v_mov_b32 v116, 0
    v_mov_b32 v117, 0
    v_mov_b32 v118, 0
    v_mov_b32 v119, 0
    v_mov_b32 v120, 0
    v_mov_b32 v121, 0
    v_mov_b32 v122, 0
    v_mov_b32 v123, 0
    v_mov_b32 v124, 0
    v_mov_b32 v125, 0
    v_mov_b32 v126, 0
    v_mov_b32 v127, 0
    v_mov_b32 v128, 0
    v_mov_b32 v129, 0
    v_mov_b32 v130, 0
    v_mov_b32 v131, 0
    v_mov_b32 v132, 0
    v_mov_b32 v133, 0
    v_mov_b32 v134, 0
    v_mov_b32 v135, 0
    v_mov_b32 v136, 0
    v_mov_b32 v137, 0
    v_mov_b32 v138, 0
    v_mov_b32 v139, 0
    v_mov_b32 v140, 0
    v_mov_b32 v141, 0
    v_mov_b32 v142, 0
    v_mov_b32 v143, 0
    buffer_load_dwordx4 v[16:19], v10, s[8:11], s48 offen sc1
    buffer_load_dwordx4 v[20:23], v10, s[8:11], s49 offen sc1
    buffer_load_dwordx4 v[24:27], v10, s[8:11], s50 offen sc1
    buffer_load_dwordx4 v[28:31], v10, s[8:11], s51 offen sc1
    buffer_load_dwordx4 v[32:35], v11, s[12:15], s52 offen
    buffer_load_dwordx4 v[36:39], v11, s[12:15], s53 offen
    buffer_load_dwordx4 v[40:43], v11, s[12:15], s54 offen
    buffer_load_dwordx4 v[44:47], v11, s[12:15], s55 offen
    s_add_u32 s48, s48, 128
    s_add_u32 s52, s52, s35
    s_add_u32 s49, s49, 128
    s_add_u32 s53, s53, s35
    s_add_u32 s50, s50, 128
    s_add_u32 s54, s54, s35
    s_add_u32 s51, s51, 128
    s_add_u32 s55, s55, s35
    buffer_load_dwordx4 v[176:179], v10, s[8:11], s48 offen sc1
    buffer_load_dwordx4 v[180:183], v10, s[8:11], s49 offen sc1
    buffer_load_dwordx4 v[184:187], v10, s[8:11], s50 offen sc1
    buffer_load_dwordx4 v[188:191], v10, s[8:11], s51 offen sc1
    buffer_load_dwordx4 v[192:195], v11, s[12:15], s52 offen
    buffer_load_dwordx4 v[196:199], v11, s[12:15], s53 offen
    buffer_load_dwordx4 v[200:203], v11, s[12:15], s54 offen
    buffer_load_dwordx4 v[204:207], v11, s[12:15], s55 offen
    s_add_u32 s48, s48, 128
    s_add_u32 s52, s52, s35
    s_add_u32 s49, s49, 128
    s_add_u32 s53, s53, s35
    s_add_u32 s50, s50, 128
    s_add_u32 s54, s54, s35
    s_add_u32 s51, s51, 128
    s_add_u32 s55, s55, s35
    s_waitcnt vmcnt(8)
    ds_write_b128 v2, v[16:19] offset:0
    ds_write_b128 v2, v[20:23] offset:4608
    ds_write_b128 v2, v[24:27] offset:9216
    ds_write_b128 v2, v[28:31] offset:13824
    ds_write_b128 v3, v[32:35] offset:0
    ds_write_b128 v3, v[36:39] offset:5120
    ds_write_b128 v3, v[40:43] offset:10240
    ds_write_b128 v3, v[44:47] offset:15360
    s_waitcnt lgkmcnt(0)
    s_barrier
    s_mov_b32 s36, 28
gloop_6:
    buffer_load_dwordx4 v[16:19], v10, s[8:11], s48 offen sc1
    buffer_load_dwordx4 v[20:23], v10, s[8:11], s49 offen sc1
    buffer_load_dwordx4 v[24:27], v10, s[8:11], s50 offen sc1
    buffer_load_dwordx4 v[28:31], v10, s[8:11], s51 offen sc1
    buffer_load_dwordx4 v[32:35], v11, s[12:15], s52 offen
    buffer_load_dwordx4 v[36:39], v11, s[12:15], s53 offen
    buffer_load_dwordx4 v[40:43], v11, s[12:15], s54 offen
    buffer_load_dwordx4 v[44:47], v11, s[12:15], s55 offen
    s_add_u32 s48, s48, 128
    s_add_u32 s52, s52, s35
    s_add_u32 s49, s49, 128
    s_add_u32 s53, s53, s35
    s_add_u32 s50, s50, 128
    s_add_u32 s54, s54, s35
    s_add_u32 s51, s51, 128
    s_add_u32 s55, s55, s35
    ds_read_b128 v[48:51], v4 offset:0
    ds_read_b128 v[52:55], v4 offset:4608
    ds_read_b64_tr_b16 v[56:57], v5 offset:0
    ds_read_b64_tr_b16 v[58:59], v5 offset:1280
    ds_read_b64_tr_b16 v[60:61], v5 offset:64
    ds_read_b64_tr_b16 v[62:63], v5 offset:1344
    ds_read_b128 v[64:67], v4 offset:32
    ds_read_b128 v[68:71], v4 offset:4640
    ds_read_b64_tr_b16 v[72:73], v5 offset:5120
    ds_read_b64_tr_b16 v[74:75], v5 offset:6400
    ds_read_b64_tr_b16 v[76:77], v5 offset:5184
    ds_read_b64_tr_b16 v[78:79], v5 offset:6464
    s_waitcnt lgkmcnt(6)
    v_mfma_f32_32x32x16_bf16 v[80:95], v[56:59], v[48:51], v[80:95]
    v_mfma_f32_32x32x16_bf16 v[96:111], v[60:63], v[48:51], v[96:111]
    v_mfma_f32_32x32x16_bf16 v[112:127], v[56:59], v[52:55], v[112:127]
    v_mfma_f32_32x32x16_bf16 v[128:143], v[60:63], v[52:55], v[128:143]
    ds_read_b128 v[48:51], v4 offset:64
    ds_read_b128 v[52:55], v4 offset:4672
    ds_read_b64_tr_b16 v[56:57], v5 offset:10240
    ds_read_b64_tr_b16 v[58:59], v5 offset:11520
    ds_read_b64_tr_b16 v[60:61], v5 offset:10304
    ds_read_b64_tr_b16 v[62:63], v5 offset:11584
    s_waitcnt lgkmcnt(6)
    v_mfma_f32_32x32x16_bf16 v[80:95], v[72:75], v[64:67], v[80:95]
    v_mfma_f32_32x32x16_bf16 v[96:111], v[76:79], v[64:67], v[96:111]
    v_mfma_f32_32x32x16_bf16 v[112:127], v[72:75], v[68:71], v[112:127]
    v_mfma_f32_32x32x16_bf16 v[128:143], v[76:79], v[68:71], v[128:143]
    ds_read_b128 v[64:67], v4 offset:96
    ds_read_b128 v[68:71], v4 offset:4704
    ds_read_b64_tr_b16 v[72:73], v5 offset:15360
    ds_read_b64_tr_b16 v[74:75], v5 offset:16640
    ds_read_b64_tr_b16 v[76:77], v5 offset:15424
    ds_read_b64_tr_b16 v[78:79], v5 offset:16704
    s_waitcnt lgkmcnt(6)
    v_mfma_f32_32x32x16_bf16 v[80:95], v[56:59], v[48:51], v[80:95]
    v_mfma_f32_32x32x16_bf16 v[96:111], v[60:63], v[48:51], v[96:111]
    v_mfma_f32_32x32x16_bf16 v[112:127], v[56:59], v[52:55], v[112:127]
    v_mfma_f32_32x32x16_bf16 v[128:143], v[60:63], v[52:55], v[128:143]
    s_waitcnt lgkmcnt(0)
    v_mfma_f32_32x32x16_bf16 v[80:95], v[72:75], v[64:67], v[80:95]
    v_mfma_f32_32x32x16_bf16 v[96:111], v[76:79], v[64:67], v[96:111]
    v_mfma_f32_32x32x16_bf16 v[112:127], v[72:75], v[68:71], v[112:127]
    v_mfma_f32_32x32x16_bf16 v[128:143], v[76:79], v[68:71], v[128:143]
    s_waitcnt vmcnt(8)
    ds_write_b128 v2, v[176:179] offset:38912
    ds_write_b128 v2, v[180:183] offset:43520
    ds_write_b128 v2, v[184:187] offset:48128
    ds_write_b128 v2, v[188:191] offset:52736
    ds_write_b128 v3, v[192:195] offset:38912
    ds_write_b128 v3, v[196:199] offset:44032
    ds_write_b128 v3, v[200:203] offset:49152
    ds_write_b128 v3, v[204:207] offset:54272
    s_waitcnt lgkmcnt(0)
    s_barrier
    buffer_load_dwordx4 v[176:179], v10, s[8:11], s48 offen sc1
    buffer_load_dwordx4 v[180:183], v10, s[8:11], s49 offen sc1
    buffer_load_dwordx4 v[184:187], v10, s[8:11], s50 offen sc1
    buffer_load_dwordx4 v[188:191], v10, s[8:11], s51 offen sc1
    buffer_load_dwordx4 v[192:195], v11, s[12:15], s52 offen
    buffer_load_dwordx4 v[196:199], v11, s[12:15], s53 offen
    buffer_load_dwordx4 v[200:203], v11, s[12:15], s54 offen
    buffer_load_dwordx4 v[204:207], v11, s[12:15], s55 offen
    s_add_u32 s48, s48, 128
    s_add_u32 s52, s52, s35
    s_add_u32 s49, s49, 128
    s_add_u32 s53, s53, s35
    s_add_u32 s50, s50, 128
    s_add_u32 s54, s54, s35
    s_add_u32 s51, s51, 128
    s_add_u32 s55, s55, s35
    ds_read_b128 v[48:51], v4 offset:38912
    ds_read_b128 v[52:55], v4 offset:43520
    ds_read_b64_tr_b16 v[56:57], v5 offset:38912
    ds_read_b64_tr_b16 v[58:59], v5 offset:40192
    ds_read_b64_tr_b16 v[60:61], v5 offset:38976
    ds_read_b64_tr_b16 v[62:63], v5 offset:40256
    ds_read_b128 v[64:67], v4 offset:38944
    ds_read_b128 v[68:71], v4 offset:43552
    ds_read_b64_tr_b16 v[72:73], v5 offset:44032
    ds_read_b64_tr_b16 v[74:75], v5 offset:45312
    ds_read_b64_tr_b16 v[76:77], v5 offset:44096
    ds_read_b64_tr_b16 v[78:79], v5 offset:45376
    s_waitcnt lgkmcnt(6)
    v_mfma_f32_32x32x16_bf16 v[80:95], v[56:59], v[48:51], v[80:95]
    v_mfma_f32_32x32x16_bf16 v[96:111], v[60:63], v[48:51], v[96:111]
    v_mfma_f32_32x32x16_bf16 v[112:127], v[56:59], v[52:55], v[112:127]
    v_mfma_f32_32x32x16_bf16 v[128:143], v[60:63], v[52:55], v[128:143]
    ds_read_b128 v[48:51], v4 offset:38976
    ds_read_b128 v[52:55], v4 offset:43584
    ds_read_b64_tr_b16 v[56:57], v5 offset:49152
    ds_read_b64_tr_b16 v[58:59], v5 offset:50432
    ds_read_b64_tr_b16 v[60:61], v5 offset:49216
    ds_read_b64_tr_b16 v[62:63], v5 offset:50496
    s_waitcnt lgkmcnt(6)
    v_mfma_f32_32x32x16_bf16 v[80:95], v[72:75], v[64:67], v[80:95]
    v_mfma_f32_32x32x16_bf16 v[96:111], v[76:79], v[64:67], v[96:111]
    v_mfma_f32_32x32x16_bf16 v[112:127], v[72:75], v[68:71], v[112:127]
    v_mfma_f32_32x32x16_bf16 v[128:143], v[76:79], v[68:71], v[128:143]
    ds_read_b128 v[64:67], v4 offset:39008
    ds_read_b128 v[68:71], v4 offset:43616
    ds_read_b64_tr_b16 v[72:73], v5 offset:54272
    ds_read_b64_tr_b16 v[74:75], v5 offset:55552
    ds_read_b64_tr_b16 v[76:77], v5 offset:54336
    ds_read_b64_tr_b16 v[78:79], v5 offset:55616
    s_waitcnt lgkmcnt(6)
    v_mfma_f32_32x32x16_bf16 v[80:95], v[56:59], v[48:51], v[80:95]
    v_mfma_f32_32x32x16_bf16 v[96:111], v[60:63], v[48:51], v[96:111]
    v_mfma_f32_32x32x16_bf16 v[112:127], v[56:59], v[52:55], v[112:127]
    v_mfma_f32_32x32x16_bf16 v[128:143], v[60:63], v[52:55], v[128:143]
    s_waitcnt lgkmcnt(0)
    v_mfma_f32_32x32x16_bf16 v[80:95], v[72:75], v[64:67], v[80:95]
    v_mfma_f32_32x32x16_bf16 v[96:111], v[76:79], v[64:67], v[96:111]
    v_mfma_f32_32x32x16_bf16 v[112:127], v[72:75], v[68:71], v[112:127]
    v_mfma_f32_32x32x16_bf16 v[128:143], v[76:79], v[68:71], v[128:143]
    s_waitcnt vmcnt(8)
    ds_write_b128 v2, v[16:19] offset:0
    ds_write_b128 v2, v[20:23] offset:4608
    ds_write_b128 v2, v[24:27] offset:9216
    ds_write_b128 v2, v[28:31] offset:13824
    ds_write_b128 v3, v[32:35] offset:0
    ds_write_b128 v3, v[36:39] offset:5120
    ds_write_b128 v3, v[40:43] offset:10240
    ds_write_b128 v3, v[44:47] offset:15360
    s_waitcnt lgkmcnt(0)
    s_barrier
    s_sub_u32 s36, s36, 1
    s_cmp_lg_u32 s36, 0
    s_cbranch_scc1 gloop_6
    s_waitcnt vmcnt(0)
    s_nop 7
    s_nop 7
    s_mov_b32 s40, s66
    s_mov_b32 s41, s67
    s_mov_b32 s42, 2048
    s_mov_b32 s43, 0x00020000
    v_lshrrev_b32 v1, 1, v7
    v_lshlrev_b32 v1, 6, v1
    v_and_b32 v8, 31, v6
    s_lshl_b32 s34, s3, 7
    v_add3_u32 v1, v1, v8, s34
    v_lshlrev_b32 v12, 11, v1
    v_and_b32 v1, 1, v7
    v_lshlrev_b32 v1, 7, v1
    v_lshrrev_b32 v8, 5, v6
    v_lshlrev_b32 v8, 3, v8
    s_lshl_b32 s34, s4, 8
    v_add3_u32 v14, v1, v8, s34
    v_add_u32 v12, v12, v14
    v_add_u32 v13, 65536, v12
    s_mov_b32 s36, 92274688
    buffer_load_dwordx2 v[16:17], v14, s[40:43], 0 offen offset:0
    buffer_load_dwordx2 v[18:19], v14, s[40:43], 0 offen offset:16
    buffer_load_dwordx2 v[20:21], v14, s[40:43], 0 offen offset:32
    buffer_load_dwordx2 v[22:23], v14, s[40:43], 0 offen offset:48
    buffer_load_dwordx2 v[24:25], v14, s[40:43], 0 offen offset:64
    buffer_load_dwordx2 v[26:27], v14, s[40:43], 0 offen offset:80
    buffer_load_dwordx2 v[28:29], v14, s[40:43], 0 offen offset:96
    buffer_load_dwordx2 v[30:31], v14, s[40:43], 0 offen offset:112
    s_waitcnt vmcnt(0)
    v_cvt_pk_bf16_f32 v80, v80, v80
    v_lshlrev_b32 v80, 16, v80
    v_lshlrev_b32 v32, 16, v16
    v_add_f32 v80, v80, v32
    v_cvt_pk_bf16_f32 v81, v81, v81
    v_lshlrev_b32 v81, 16, v81
    v_and_b32 v32, 0xffff0000, v16
    v_add_f32 v81, v81, v32
    v_cvt_pk_bf16_f32 v82, v82, v82
    v_lshlrev_b32 v82, 16, v82
    v_lshlrev_b32 v32, 16, v17
    v_add_f32 v82, v82, v32
    v_cvt_pk_bf16_f32 v83, v83, v83
    v_lshlrev_b32 v83, 16, v83
    v_and_b32 v32, 0xffff0000, v17
    v_add_f32 v83, v83, v32
    v_cvt_pk_bf16_f32 v36, v80, v81
    v_cvt_pk_bf16_f32 v37, v82, v83
    buffer_store_dwordx2 v[36:37], v12, s[8:11], s36 offen offset:0 sc1
    s_nop 1
    v_cvt_pk_bf16_f32 v84, v84, v84
    v_lshlrev_b32 v84, 16, v84
    v_lshlrev_b32 v32, 16, v18
    v_add_f32 v84, v84, v32
    v_cvt_pk_bf16_f32 v85, v85, v85
    v_lshlrev_b32 v85, 16, v85
    v_and_b32 v32, 0xffff0000, v18
    v_add_f32 v85, v85, v32
    v_cvt_pk_bf16_f32 v86, v86, v86
    v_lshlrev_b32 v86, 16, v86
    v_lshlrev_b32 v32, 16, v19
    v_add_f32 v86, v86, v32
    v_cvt_pk_bf16_f32 v87, v87, v87
    v_lshlrev_b32 v87, 16, v87
    v_and_b32 v32, 0xffff0000, v19
    v_add_f32 v87, v87, v32
    v_cvt_pk_bf16_f32 v36, v84, v85
    v_cvt_pk_bf16_f32 v37, v86, v87
    buffer_store_dwordx2 v[36:37], v12, s[8:11], s36 offen offset:16 sc1
    s_nop 1
    v_cvt_pk_bf16_f32 v88, v88, v88
    v_lshlrev_b32 v88, 16, v88
    v_lshlrev_b32 v32, 16, v20
    v_add_f32 v88, v88, v32
    v_cvt_pk_bf16_f32 v89, v89, v89
    v_lshlrev_b32 v89, 16, v89
    v_and_b32 v32, 0xffff0000, v20
    v_add_f32 v89, v89, v32
    v_cvt_pk_bf16_f32 v90, v90, v90
    v_lshlrev_b32 v90, 16, v90
    v_lshlrev_b32 v32, 16, v21
    v_add_f32 v90, v90, v32
    v_cvt_pk_bf16_f32 v91, v91, v91
    v_lshlrev_b32 v91, 16, v91
    v_and_b32 v32, 0xffff0000, v21
    v_add_f32 v91, v91, v32
    v_cvt_pk_bf16_f32 v36, v88, v89
    v_cvt_pk_bf16_f32 v37, v90, v91
    buffer_store_dwordx2 v[36:37], v12, s[8:11], s36 offen offset:32 sc1
    s_nop 1
    v_cvt_pk_bf16_f32 v92, v92, v92
    v_lshlrev_b32 v92, 16, v92
    v_lshlrev_b32 v32, 16, v22
    v_add_f32 v92, v92, v32
    v_cvt_pk_bf16_f32 v93, v93, v93
    v_lshlrev_b32 v93, 16, v93
    v_and_b32 v32, 0xffff0000, v22
    v_add_f32 v93, v93, v32
    v_cvt_pk_bf16_f32 v94, v94, v94
    v_lshlrev_b32 v94, 16, v94
    v_lshlrev_b32 v32, 16, v23
    v_add_f32 v94, v94, v32
    v_cvt_pk_bf16_f32 v95, v95, v95
    v_lshlrev_b32 v95, 16, v95
    v_and_b32 v32, 0xffff0000, v23
    v_add_f32 v95, v95, v32
    v_cvt_pk_bf16_f32 v36, v92, v93
    v_cvt_pk_bf16_f32 v37, v94, v95
    buffer_store_dwordx2 v[36:37], v12, s[8:11], s36 offen offset:48 sc1
    s_nop 1
    v_cvt_pk_bf16_f32 v96, v96, v96
    v_lshlrev_b32 v96, 16, v96
    v_lshlrev_b32 v32, 16, v24
    v_add_f32 v96, v96, v32
    v_cvt_pk_bf16_f32 v97, v97, v97
    v_lshlrev_b32 v97, 16, v97
    v_and_b32 v32, 0xffff0000, v24
    v_add_f32 v97, v97, v32
    v_cvt_pk_bf16_f32 v98, v98, v98
    v_lshlrev_b32 v98, 16, v98
    v_lshlrev_b32 v32, 16, v25
    v_add_f32 v98, v98, v32
    v_cvt_pk_bf16_f32 v99, v99, v99
    v_lshlrev_b32 v99, 16, v99
    v_and_b32 v32, 0xffff0000, v25
    v_add_f32 v99, v99, v32
    v_cvt_pk_bf16_f32 v36, v96, v97
    v_cvt_pk_bf16_f32 v37, v98, v99
    buffer_store_dwordx2 v[36:37], v12, s[8:11], s36 offen offset:64 sc1
    s_nop 1
    v_cvt_pk_bf16_f32 v100, v100, v100
    v_lshlrev_b32 v100, 16, v100
    v_lshlrev_b32 v32, 16, v26
    v_add_f32 v100, v100, v32
    v_cvt_pk_bf16_f32 v101, v101, v101
    v_lshlrev_b32 v101, 16, v101
    v_and_b32 v32, 0xffff0000, v26
    v_add_f32 v101, v101, v32
    v_cvt_pk_bf16_f32 v102, v102, v102
    v_lshlrev_b32 v102, 16, v102
    v_lshlrev_b32 v32, 16, v27
    v_add_f32 v102, v102, v32
    v_cvt_pk_bf16_f32 v103, v103, v103
    v_lshlrev_b32 v103, 16, v103
    v_and_b32 v32, 0xffff0000, v27
    v_add_f32 v103, v103, v32
    v_cvt_pk_bf16_f32 v36, v100, v101
    v_cvt_pk_bf16_f32 v37, v102, v103
    buffer_store_dwordx2 v[36:37], v12, s[8:11], s36 offen offset:80 sc1
    s_nop 1
    v_cvt_pk_bf16_f32 v104, v104, v104
    v_lshlrev_b32 v104, 16, v104
    v_lshlrev_b32 v32, 16, v28
    v_add_f32 v104, v104, v32
    v_cvt_pk_bf16_f32 v105, v105, v105
    v_lshlrev_b32 v105, 16, v105
    v_and_b32 v32, 0xffff0000, v28
    v_add_f32 v105, v105, v32
    v_cvt_pk_bf16_f32 v106, v106, v106
    v_lshlrev_b32 v106, 16, v106
    v_lshlrev_b32 v32, 16, v29
    v_add_f32 v106, v106, v32
    v_cvt_pk_bf16_f32 v107, v107, v107
    v_lshlrev_b32 v107, 16, v107
    v_and_b32 v32, 0xffff0000, v29
    v_add_f32 v107, v107, v32
    v_cvt_pk_bf16_f32 v36, v104, v105
    v_cvt_pk_bf16_f32 v37, v106, v107
    buffer_store_dwordx2 v[36:37], v12, s[8:11], s36 offen offset:96 sc1
    s_nop 1
    v_cvt_pk_bf16_f32 v108, v108, v108
    v_lshlrev_b32 v108, 16, v108
    v_lshlrev_b32 v32, 16, v30
    v_add_f32 v108, v108, v32
    v_cvt_pk_bf16_f32 v109, v109, v109
    v_lshlrev_b32 v109, 16, v109
    v_and_b32 v32, 0xffff0000, v30
    v_add_f32 v109, v109, v32
    v_cvt_pk_bf16_f32 v110, v110, v110
    v_lshlrev_b32 v110, 16, v110
    v_lshlrev_b32 v32, 16, v31
    v_add_f32 v110, v110, v32
    v_cvt_pk_bf16_f32 v111, v111, v111
    v_lshlrev_b32 v111, 16, v111
    v_and_b32 v32, 0xffff0000, v31
    v_add_f32 v111, v111, v32
    v_cvt_pk_bf16_f32 v36, v108, v109
    v_cvt_pk_bf16_f32 v37, v110, v111
    buffer_store_dwordx2 v[36:37], v12, s[8:11], s36 offen offset:112 sc1
    s_nop 1
    v_cvt_pk_bf16_f32 v112, v112, v112
    v_lshlrev_b32 v112, 16, v112
    v_lshlrev_b32 v32, 16, v16
    v_add_f32 v112, v112, v32
    v_cvt_pk_bf16_f32 v113, v113, v113
    v_lshlrev_b32 v113, 16, v113
    v_and_b32 v32, 0xffff0000, v16
    v_add_f32 v113, v113, v32
    v_cvt_pk_bf16_f32 v114, v114, v114
    v_lshlrev_b32 v114, 16, v114
    v_lshlrev_b32 v32, 16, v17
    v_add_f32 v114, v114, v32
    v_cvt_pk_bf16_f32 v115, v115, v115
    v_lshlrev_b32 v115, 16, v115
    v_and_b32 v32, 0xffff0000, v17
    v_add_f32 v115, v115, v32
    v_cvt_pk_bf16_f32 v36, v112, v113
    v_cvt_pk_bf16_f32 v37, v114, v115
    buffer_store_dwordx2 v[36:37], v13, s[8:11], s36 offen offset:0 sc1
    s_nop 1
    v_cvt_pk_bf16_f32 v116, v116, v116
    v_lshlrev_b32 v116, 16, v116
    v_lshlrev_b32 v32, 16, v18
    v_add_f32 v116, v116, v32
    v_cvt_pk_bf16_f32 v117, v117, v117
    v_lshlrev_b32 v117, 16, v117
    v_and_b32 v32, 0xffff0000, v18
    v_add_f32 v117, v117, v32
    v_cvt_pk_bf16_f32 v118, v118, v118
    v_lshlrev_b32 v118, 16, v118
    v_lshlrev_b32 v32, 16, v19
    v_add_f32 v118, v118, v32
    v_cvt_pk_bf16_f32 v119, v119, v119
    v_lshlrev_b32 v119, 16, v119
    v_and_b32 v32, 0xffff0000, v19
    v_add_f32 v119, v119, v32
    v_cvt_pk_bf16_f32 v36, v116, v117
    v_cvt_pk_bf16_f32 v37, v118, v119
    buffer_store_dwordx2 v[36:37], v13, s[8:11], s36 offen offset:16 sc1
    s_nop 1
    v_cvt_pk_bf16_f32 v120, v120, v120
    v_lshlrev_b32 v120, 16, v120
    v_lshlrev_b32 v32, 16, v20
    v_add_f32 v120, v120, v32
    v_cvt_pk_bf16_f32 v121, v121, v121
    v_lshlrev_b32 v121, 16, v121
    v_and_b32 v32, 0xffff0000, v20
    v_add_f32 v121, v121, v32
    v_cvt_pk_bf16_f32 v122, v122, v122
    v_lshlrev_b32 v122, 16, v122
    v_lshlrev_b32 v32, 16, v21
    v_add_f32 v122, v122, v32
    v_cvt_pk_bf16_f32 v123, v123, v123
    v_lshlrev_b32 v123, 16, v123
    v_and_b32 v32, 0xffff0000, v21
    v_add_f32 v123, v123, v32
    v_cvt_pk_bf16_f32 v36, v120, v121
    v_cvt_pk_bf16_f32 v37, v122, v123
    buffer_store_dwordx2 v[36:37], v13, s[8:11], s36 offen offset:32 sc1
    s_nop 1
    v_cvt_pk_bf16_f32 v124, v124, v124
    v_lshlrev_b32 v124, 16, v124
    v_lshlrev_b32 v32, 16, v22
    v_add_f32 v124, v124, v32
    v_cvt_pk_bf16_f32 v125, v125, v125
    v_lshlrev_b32 v125, 16, v125
    v_and_b32 v32, 0xffff0000, v22
    v_add_f32 v125, v125, v32
    v_cvt_pk_bf16_f32 v126, v126, v126
    v_lshlrev_b32 v126, 16, v126
    v_lshlrev_b32 v32, 16, v23
    v_add_f32 v126, v126, v32
    v_cvt_pk_bf16_f32 v127, v127, v127
    v_lshlrev_b32 v127, 16, v127
    v_and_b32 v32, 0xffff0000, v23
    v_add_f32 v127, v127, v32
    v_cvt_pk_bf16_f32 v36, v124, v125
    v_cvt_pk_bf16_f32 v37, v126, v127
    buffer_store_dwordx2 v[36:37], v13, s[8:11], s36 offen offset:48 sc1
    s_nop 1
    v_cvt_pk_bf16_f32 v128, v128, v128
    v_lshlrev_b32 v128, 16, v128
    v_lshlrev_b32 v32, 16, v24
    v_add_f32 v128, v128, v32
    v_cvt_pk_bf16_f32 v129, v129, v129
    v_lshlrev_b32 v129, 16, v129
    v_and_b32 v32, 0xffff0000, v24
    v_add_f32 v129, v129, v32
    v_cvt_pk_bf16_f32 v130, v130, v130
    v_lshlrev_b32 v130, 16, v130
    v_lshlrev_b32 v32, 16, v25
    v_add_f32 v130, v130, v32
    v_cvt_pk_bf16_f32 v131, v131, v131
    v_lshlrev_b32 v131, 16, v131
    v_and_b32 v32, 0xffff0000, v25
    v_add_f32 v131, v131, v32
    v_cvt_pk_bf16_f32 v36, v128, v129
    v_cvt_pk_bf16_f32 v37, v130, v131
    buffer_store_dwordx2 v[36:37], v13, s[8:11], s36 offen offset:64 sc1
    s_nop 1
    v_cvt_pk_bf16_f32 v132, v132, v132
    v_lshlrev_b32 v132, 16, v132
    v_lshlrev_b32 v32, 16, v26
    v_add_f32 v132, v132, v32
    v_cvt_pk_bf16_f32 v133, v133, v133
    v_lshlrev_b32 v133, 16, v133
    v_and_b32 v32, 0xffff0000, v26
    v_add_f32 v133, v133, v32
    v_cvt_pk_bf16_f32 v134, v134, v134
    v_lshlrev_b32 v134, 16, v134
    v_lshlrev_b32 v32, 16, v27
    v_add_f32 v134, v134, v32
    v_cvt_pk_bf16_f32 v135, v135, v135
    v_lshlrev_b32 v135, 16, v135
    v_and_b32 v32, 0xffff0000, v27
    v_add_f32 v135, v135, v32
    v_cvt_pk_bf16_f32 v36, v132, v133
    v_cvt_pk_bf16_f32 v37, v134, v135
    buffer_store_dwordx2 v[36:37], v13, s[8:11], s36 offen offset:80 sc1
    s_nop 1
    v_cvt_pk_bf16_f32 v136, v136, v136
    v_lshlrev_b32 v136, 16, v136
    v_lshlrev_b32 v32, 16, v28
    v_add_f32 v136, v136, v32
    v_cvt_pk_bf16_f32 v137, v137, v137
    v_lshlrev_b32 v137, 16, v137
    v_and_b32 v32, 0xffff0000, v28
    v_add_f32 v137, v137, v32
    v_cvt_pk_bf16_f32 v138, v138, v138
    v_lshlrev_b32 v138, 16, v138
    v_lshlrev_b32 v32, 16, v29
    v_add_f32 v138, v138, v32
    v_cvt_pk_bf16_f32 v139, v139, v139
    v_lshlrev_b32 v139, 16, v139
    v_and_b32 v32, 0xffff0000, v29
    v_add_f32 v139, v139, v32
    v_cvt_pk_bf16_f32 v36, v136, v137
    v_cvt_pk_bf16_f32 v37, v138, v139
    buffer_store_dwordx2 v[36:37], v13, s[8:11], s36 offen offset:96 sc1
    s_nop 1
    v_cvt_pk_bf16_f32 v140, v140, v140
    v_lshlrev_b32 v140, 16, v140
    v_lshlrev_b32 v32, 16, v30
    v_add_f32 v140, v140, v32
    v_cvt_pk_bf16_f32 v141, v141, v141
    v_lshlrev_b32 v141, 16, v141
    v_and_b32 v32, 0xffff0000, v30
    v_add_f32 v141, v141, v32
    v_cvt_pk_bf16_f32 v142, v142, v142
    v_lshlrev_b32 v142, 16, v142
    v_lshlrev_b32 v32, 16, v31
    v_add_f32 v142, v142, v32
    v_cvt_pk_bf16_f32 v143, v143, v143
    v_lshlrev_b32 v143, 16, v143
    v_and_b32 v32, 0xffff0000, v31
    v_add_f32 v143, v143, v32
    v_cvt_pk_bf16_f32 v36, v140, v141
    v_cvt_pk_bf16_f32 v37, v142, v143
    buffer_store_dwordx2 v[36:37], v13, s[8:11], s36 offen offset:112 sc1
    s_nop 1
    s_lshl_b32 s7, s3, 2
    s_add_u32 s7, s7, 192
    s_waitcnt vmcnt(0)
    s_barrier
    v_mov_b32 v1, 1
    s_add_u32 s5, s7, 117440512
    v_mov_b32 v2, s5
    v_cmp_eq_u32 vcc, 0, v0
    s_and_saveexec_b64 s[46:47], vcc
    buffer_atomic_add v1, v2, s[8:11], 0 offen sc1
    s_mov_b64 exec, s[46:47]
wk_attn:
    s_and_b32 s59, s60, 1
    s_mov_b32 s73, 0
wk_p4:
    s_load_dwordx2 s[28:29], s[0:1], 112
    s_waitcnt lgkmcnt(0)
    s_mov_b32 s8, s28
    s_mov_b32 s9, s29
    s_mov_b32 s10, 268435456
    s_mov_b32 s11, 0x00020000
    s_mov_b32 s74, s73
    s_cmp_ge_u32 s60, 128
    s_cbranch_scc1 wk_p4k
    s_cmp_eq_u32 s73, 2
    s_cbranch_scc1 wk_p4k
    s_xor_b32 s74, s73, 1
wk_p4k:
    s_cmp_eq_u32 s74, 1
    s_cbranch_scc0 wk_tile
    s_lshr_b32 s16, s60, 2
    s_lshr_b32 s7, s16, 2
    s_lshl_b32 s7, s7, 2
    s_add_u32 s7, s7, 128
    s_add_u32 s5, s7, 117440512
    v_mov_b32 v2, s5
    s_mov_b32 s6, 0
    v_lshrrev_b32 v1, 6, v0
    s_nop 1
    v_readfirstlane_b32 s75, v1
    s_nop 3
    s_cmp_lg_u32 s75, 0
    s_cbranch_scc1 wk_g_8
wk_w_7:
    buffer_load_dword v1, v2, s[8:11], 0 offen sc1
    s_waitcnt vmcnt(0)
    v_cmp_le_u32 vcc, 32, v1
    s_cbranch_vccnz wk_g_8
    s_sleep 48
    s_add_u32 s6, s6, 1
    s_cmp_lt_u32 s6, 0x80000
    s_cbranch_scc1 wk_w_7
wk_g_8:
    s_barrier
    s_mov_b32 s58, 0
wk_at_loop:
    s_lshr_b32 s16, s60, 2
    s_and_b32 s17, s60, 3
    s_lshl_b32 s17, s17, 3
    s_add_u32 s17, s17, s58
    v_and_b32 v1, 63, v0
    v_lshrrev_b32 v2, 6, v0
    v_and_b32 v3, 15, v1
    v_lshrrev_b32 v4, 4, v1
    s_nop 1
    v_readfirstlane_b32 s18, v2
    s_nop 3
    s_add_u32 s17, s17, s18
    v_lshlrev_b32 v5, 13, v3
    v_lshlrev_b32 v6, 4, v4
    v_add_u32 v5, v5, v6
    s_lshl_b32 s20, s16, 18
    s_lshl_b32 s21, s17, 8
    s_add_u32 s20, s20, s21
    s_add_u32 s21, s20, 8388608
    s_add_u32 s22, s21, 0x20000
    buffer_load_dwordx4 v[32:35], v5, s[8:11], s21 offen offset:0 sc1
    buffer_load_dwordx4 v[36:39], v5, s[8:11], s21 offen offset:64 sc1
    buffer_load_dwordx4 v[40:43], v5, s[8:11], s21 offen offset:128 sc1
    buffer_load_dwordx4 v[44:47], v5, s[8:11], s21 offen offset:192 sc1
    buffer_load_dwordx4 v[48:51], v5, s[8:11], s22 offen offset:0 sc1
    buffer_load_dwordx4 v[52:55], v5, s[8:11], s22 offen offset:64 sc1
    buffer_load_dwordx4 v[56:59], v5, s[8:11], s22 offen offset:128 sc1
    buffer_load_dwordx4 v[60:63], v5, s[8:11], s22 offen offset:192 sc1
    s_add_u32 s21, s20, 25165824
    s_add_u32 s22, s21, 0x20000
    buffer_load_dwordx4 v[64:67], v5, s[8:11], s21 offen offset:0 sc1
    buffer_load_dwordx4 v[68:71], v5, s[8:11], s21 offen offset:64 sc1
    buffer_load_dwordx4 v[72:75], v5, s[8:11], s21 offen offset:128 sc1
    buffer_load_dwordx4 v[76:79], v5, s[8:11], s21 offen offset:192 sc1
    buffer_load_dwordx4 v[80:83], v5, s[8:11], s22 offen offset:0 sc1
    buffer_load_dwordx4 v[84:87], v5, s[8:11], s22 offen offset:64 sc1
    buffer_load_dwordx4 v[88:91], v5, s[8:11], s22 offen offset:128 sc1
    buffer_load_dwordx4 v[92:95], v5, s[8:11], s22 offen offset:192 sc1
    s_mul_i32 s23, s16, 196608
    s_mul_i32 s24, s17, 6144
    s_add_u32 s23, s23, s24
    s_add_u32 s23, s23, 102760448
    v_and_b32 v7, 7, v3
    v_lshlrev_b32 v7, 6, v7
    v_add_u32 v7, v7, v6
    s_add_u32 s26, s23, 0xc00
    v_lshlrev_b32 v8, 6, v3
    v_lshlrev_b32 v9, 3, v4
    v_add_u32 v8, v8, v9
    s_lshl_b32 s24, s16, 18
    s_lshl_b32 s25, s17, 13
    s_add_u32 s24, s24, s25
    s_add_u32 s24, s24, 41943040
    s_add_u32 s25, s24, 0x1000
    buffer_load_dwordx2 v[112:113], v8, s[8:11], s24 offen offset:0 sc1
    buffer_load_dwordx2 v[114:115], v8, s[8:11], s24 offen offset:32 sc1
    buffer_load_dwordx2 v[116:117], v8, s[8:11], s24 offen offset:1024 sc1
    buffer_load_dwordx2 v[118:119], v8, s[8:11], s24 offen offset:1056 sc1
    buffer_load_dwordx2 v[120:121], v8, s[8:11], s24 offen offset:2048 sc1
    buffer_load_dwordx2 v[122:123], v8, s[8:11], s24 offen offset:2080 sc1
    buffer_load_dwordx2 v[124:125], v8, s[8:11], s24 offen offset:3072 sc1
    buffer_load_dwordx2 v[126:127], v8, s[8:11], s24 offen offset:3104 sc1
    buffer_load_dwordx2 v[128:129], v8, s[8:11], s25 offen offset:0 sc1
    buffer_load_dwordx2 v[130:131], v8, s[8:11], s25 offen offset:32 sc1
    buffer_load_dwordx2 v[132:133], v8, s[8:11], s25 offen offset:1024 sc1
    buffer_load_dwordx2 v[134:135], v8, s[8:11], s25 offen offset:1056 sc1
    buffer_load_dwordx2 v[136:137], v8, s[8:11], s25 offen offset:2048 sc1
    buffer_load_dwordx2 v[138:139], v8, s[8:11], s25 offen offset:2080 sc1
    buffer_load_dwordx2 v[140:141], v8, s[8:11], s25 offen offset:3072 sc1
    buffer_load_dwordx2 v[142:143], v8, s[8:11], s25 offen offset:3104 sc1
    v_lshlrev_b32 v9, 4, v3
    v_and_b32 v10, 1, v4
    v_lshlrev_b32 v10, 3, v10
    v_add_u32 v9, v9, v10
    s_mov_b32 s19, 0
    v_and_b32 v27, 3, v1
    v_mul_u32_u24 v27, 1536, v27
    v_add_u32 v27, 1532, v27
wka_pp_11:
    buffer_load_dword v28, v27, s[8:11], s23 offen sc1
    s_waitcnt vmcnt(0)
    v_cmp_eq_u32 vcc, -1, v28
    s_cbranch_vccz wka_poll_9
    s_sleep 48
    s_add_u32 s19, s19, 1
    s_cmp_lt_u32 s19, 0x80000
    s_cbranch_scc1 wka_pp_11
wka_poll_9:
    buffer_load_dwordx4 v[96:99], v7, s[8:11], s23 offen offset:512 sc1
    buffer_load_dwordx4 v[100:103], v7, s[8:11], s23 offen offset:2048 sc1
    buffer_load_dwordx4 v[104:107], v7, s[8:11], s26 offen offset:512 sc1
    buffer_load_dwordx4 v[108:111], v7, s[8:11], s26 offen offset:2048 sc1
    buffer_load_dwordx2 v[144:145], v9, s[8:11], s23 offen offset:1024 sc1
    buffer_load_dwordx2 v[148:149], v9, s[8:11], s23 offen offset:1280 sc1
    buffer_load_dwordx2 v[152:153], v9, s[8:11], s23 offen offset:2560 sc1
    buffer_load_dwordx2 v[156:157], v9, s[8:11], s23 offen offset:2816 sc1
    buffer_load_dwordx2 v[160:161], v9, s[8:11], s26 offen offset:1024 sc1
    buffer_load_dwordx2 v[164:165], v9, s[8:11], s26 offen offset:1280 sc1
    buffer_load_dwordx2 v[168:169], v9, s[8:11], s26 offen offset:2560 sc1
    buffer_load_dwordx2 v[172:173], v9, s[8:11], s26 offen offset:2816 sc1
    s_waitcnt vmcnt(0)
    v_max_u32 v27, v96, v97
    v_max3_u32 v27, v27, v98, v99
    v_max3_u32 v27, v27, v100, v101
    v_max3_u32 v27, v27, v102, v103
    v_max3_u32 v27, v27, v104, v105
    v_max3_u32 v27, v27, v106, v107
    v_max3_u32 v27, v27, v108, v109
    v_max3_u32 v27, v27, v110, v111
    v_max3_u32 v27, v27, v144, v145
    v_max3_u32 v27, v27, v148, v149
    v_max3_u32 v27, v27, v152, v153
    v_max3_u32 v27, v27, v156, v157
    v_max3_u32 v27, v27, v160, v161
    v_max3_u32 v27, v27, v164, v165
    v_max3_u32 v27, v27, v168, v169
    v_max3_u32 v27, v27, v172, v173
    v_cmp_eq_u32 vcc, -1, v27
    s_cbranch_vccz wka_pd_10
    s_sleep 16
    s_add_u32 s19, s19, 1
    s_cmp_lt_u32 s19, 0x100000
    s_cbranch_scc1 wka_poll_9
wka_pd_10:
    v_mov_b32 v176, 0
    v_mov_b32 v177, 0
    v_mov_b32 v178, 0
    v_mov_b32 v179, 0
    v_mov_b32 v180, 0
    v_mov_b32 v181, 0
    v_mov_b32 v182, 0
    v_mov_b32 v183, 0
    v_mov_b32 v184, 0
    v_mov_b32 v185, 0
    v_mov_b32 v186, 0
    v_mov_b32 v187, 0
    v_mov_b32 v188, 0
    v_mov_b32 v189, 0
    v_mov_b32 v190, 0
    v_mov_b32 v191, 0
    v_mov_b32 v192, 0
    v_mov_b32 v193, 0
    v_mov_b32 v194, 0
    v_mov_b32 v195, 0
    v_mov_b32 v196, 0
    v_mov_b32 v197, 0
    v_mov_b32 v198, 0
    v_mov_b32 v199, 0
    v_xor_b32 v20, 16, v1
    v_lshlrev_b32 v20, 2, v20
    v_xor_b32 v21, 32, v1
    v_lshlrev_b32 v21, 2, v21
    v_mfma_f32_16x16x32_bf16 v[176:179], v[64:67], v[32:35], v[176:179]
    v_mfma_f32_16x16x32_bf16 v[180:183], v[80:83], v[32:35], v[180:183]
    v_mfma_f32_16x16x32_bf16 v[184:187], v[96:99], v[32:35], v[184:187]
    v_mfma_f32_16x16x32_bf16 v[176:179], v[68:71], v[36:39], v[176:179]
    v_mfma_f32_16x16x32_bf16 v[180:183], v[84:87], v[36:39], v[180:183]
    v_mfma_f32_16x16x32_bf16 v[184:187], v[100:103], v[36:39], v[184:187]
    v_mfma_f32_16x16x32_bf16 v[176:179], v[72:75], v[40:43], v[176:179]
    v_mfma_f32_16x16x32_bf16 v[180:183], v[88:91], v[40:43], v[180:183]
    v_mfma_f32_16x16x32_bf16 v[184:187], v[104:107], v[40:43], v[184:187]
    v_mfma_f32_16x16x32_bf16 v[176:179], v[76:79], v[44:47], v[176:179]
    v_mfma_f32_16x16x32_bf16 v[180:183], v[92:95], v[44:47], v[180:183]
    v_mfma_f32_16x16x32_bf16 v[184:187], v[108:111], v[44:47], v[184:187]
    v_mfma_f32_16x16x32_bf16 v[188:191], v[64:67], v[48:51], v[188:191]
    v_mfma_f32_16x16x32_bf16 v[192:195], v[80:83], v[48:51], v[192:195]
    v_mfma_f32_16x16x32_bf16 v[196:199], v[96:99], v[48:51], v[196:199]
    v_mfma_f32_16x16x32_bf16 v[188:191], v[68:71], v[52:55], v[188:191]
    v_mfma_f32_16x16x32_bf16 v[192:195], v[84:87], v[52:55], v[192:195]
    v_mfma_f32_16x16x32_bf16 v[196:199], v[100:103], v[52:55], v[196:199]
    v_mfma_f32_16x16x32_bf16 v[188:191], v[72:75], v[56:59], v[188:191]
    v_mfma_f32_16x16x32_bf16 v[192:195], v[88:91], v[56:59], v[192:195]
    v_mfma_f32_16x16x32_bf16 v[196:199], v[104:107], v[56:59], v[196:199]
    v_mfma_f32_16x16x32_bf16 v[188:191], v[76:79], v[60:63], v[188:191]
    v_mfma_f32_16x16x32_bf16 v[192:195], v[92:95], v[60:63], v[192:195]
    v_mfma_f32_16x16x32_bf16 v[196:199], v[108:111], v[60:63], v[196:199]
    s_waitcnt vmcnt(0)
    v_cmp_gt_u32 vcc, 2, v4
    s_nop 1
    v_cndmask_b32 v144, 0, v144, vcc
    v_cndmask_b32 v145, 0, v145, vcc
    v_mov_b32 v146, 0
    v_mov_b32 v147, 0
    v_cndmask_b32 v148, 0, v148, vcc
    v_cndmask_b32 v149, 0, v149, vcc
    v_mov_b32 v150, 0
    v_mov_b32 v151, 0
    v_cndmask_b32 v152, 0, v152, vcc
    v_cndmask_b32 v153, 0, v153, vcc
    v_mov_b32 v154, 0
    v_mov_b32 v155, 0
    v_cndmask_b32 v156, 0, v156, vcc
    v_cndmask_b32 v157, 0, v157, vcc
    v_mov_b32 v158, 0
    v_mov_b32 v159, 0
    v_cndmask_b32 v160, 0, v160, vcc
    v_cndmask_b32 v161, 0, v161, vcc
    v_mov_b32 v162, 0
    v_mov_b32 v163, 0
    v_cndmask_b32 v164, 0, v164, vcc
    v_cndmask_b32 v165, 0, v165, vcc
    v_mov_b32 v166, 0
    v_mov_b32 v167, 0
    v_cndmask_b32 v168, 0, v168, vcc
    v_cndmask_b32 v169, 0, v169, vcc
    v_mov_b32 v170, 0
    v_mov_b32 v171, 0
    v_cndmask_b32 v172, 0, v172, vcc
    v_cndmask_b32 v173, 0, v173, vcc
    v_mov_b32 v174, 0
    v_mov_b32 v175, 0
    s_mov_b32 s27, 1035273459
    s_mov_b32 s28, 1069066811
    v_mov_b32 v22, 0xff800000
    v_lshlrev_b32 v23, 13, v3
    v_lshlrev_b32 v24, 3, v4
    v_add_u32 v23, v23, v24
    s_add_u32 s29, s20, 75497472
    v_cvt_pk_bf16_f32 v176, v176, v176
    v_lshlrev_b32 v176, 16, v176
    v_mul_f32 v176, s27, v176
    v_cvt_pk_bf16_f32 v176, v176, v176
    v_lshlrev_b32 v176, 16, v176
    v_cvt_pk_bf16_f32 v177, v177, v177
    v_lshlrev_b32 v177, 16, v177
    v_mul_f32 v177, s27, v177
    v_cvt_pk_bf16_f32 v177, v177, v177
    v_lshlrev_b32 v177, 16, v177
    v_cvt_pk_bf16_f32 v178, v178, v178
    v_lshlrev_b32 v178, 16, v178
    v_mul_f32 v178, s27, v178
    v_cvt_pk_bf16_f32 v178, v178, v178
    v_lshlrev_b32 v178, 16, v178
    v_cvt_pk_bf16_f32 v179, v179, v179
    v_lshlrev_b32 v179, 16, v179
    v_mul_f32 v179, s27, v179
    v_cvt_pk_bf16_f32 v179, v179, v179
    v_lshlrev_b32 v179, 16, v179
    v_cvt_pk_bf16_f32 v180, v180, v180
    v_lshlrev_b32 v180, 16, v180
    v_mul_f32 v180, s27, v180
    v_cvt_pk_bf16_f32 v180, v180, v180
    v_lshlrev_b32 v180, 16, v180
    v_cvt_pk_bf16_f32 v181, v181, v181
    v_lshlrev_b32 v181, 16, v181
    v_mul_f32 v181, s27, v181
    v_cvt_pk_bf16_f32 v181, v181, v181
    v_lshlrev_b32 v181, 16, v181
    v_cvt_pk_bf16_f32 v182, v182, v182
    v_lshlrev_b32 v182, 16, v182
    v_mul_f32 v182, s27, v182
    v_cvt_pk_bf16_f32 v182, v182, v182
    v_lshlrev_b32 v182, 16, v182
    v_cvt_pk_bf16_f32 v183, v183, v183
    v_lshlrev_b32 v183, 16, v183
    v_mul_f32 v183, s27, v183
    v_cvt_pk_bf16_f32 v183, v183, v183
    v_lshlrev_b32 v183, 16, v183
    v_cvt_pk_bf16_f32 v184, v184, v184
    v_lshlrev_b32 v184, 16, v184
    v_mul_f32 v184, s27, v184
    v_cvt_pk_bf16_f32 v184, v184, v184
    v_lshlrev_b32 v184, 16, v184
    v_cvt_pk_bf16_f32 v185, v185, v185
    v_lshlrev_b32 v185, 16, v185
    v_mul_f32 v185, s27, v185
    v_cvt_pk_bf16_f32 v185, v185, v185
    v_lshlrev_b32 v185, 16, v185
    v_cvt_pk_bf16_f32 v186, v186, v186
    v_lshlrev_b32 v186, 16, v186
    v_mul_f32 v186, s27, v186
    v_cvt_pk_bf16_f32 v186, v186, v186
    v_lshlrev_b32 v186, 16, v186
    v_cvt_pk_bf16_f32 v187, v187, v187
    v_lshlrev_b32 v187, 16, v187
    v_mul_f32 v187, s27, v187
    v_cvt_pk_bf16_f32 v187, v187, v187
    v_lshlrev_b32 v187, 16, v187
    v_lshlrev_b32 v24, 2, v4
    v_add_u32 v25, 0, v24
    v_cmp_le_i32 vcc, v25, v3
    s_nop 1
    v_cndmask_b32 v176, v22, v176, vcc
    v_add_u32 v25, 1, v24
    v_cmp_le_i32 vcc, v25, v3
    s_nop 1
    v_cndmask_b32 v177, v22, v177, vcc
    v_add_u32 v25, 2, v24
    v_cmp_le_i32 vcc, v25, v3
    s_nop 1
    v_cndmask_b32 v178, v22, v178, vcc
    v_add_u32 v25, 3, v24
    v_cmp_le_i32 vcc, v25, v3
    s_nop 1
    v_cndmask_b32 v179, v22, v179, vcc
    v_add_u32 v25, 16, v24
    v_cmp_le_i32 vcc, v25, v3
    s_nop 1
    v_cndmask_b32 v180, v22, v180, vcc
    v_add_u32 v25, 17, v24
    v_cmp_le_i32 vcc, v25, v3
    s_nop 1
    v_cndmask_b32 v181, v22, v181, vcc
    v_add_u32 v25, 18, v24
    v_cmp_le_i32 vcc, v25, v3
    s_nop 1
    v_cndmask_b32 v182, v22, v182, vcc
    v_add_u32 v25, 19, v24
    v_cmp_le_i32 vcc, v25, v3
    s_nop 1
    v_cndmask_b32 v183, v22, v183, vcc
    v_cmp_gt_u32 vcc, 2, v4
    s_nop 1
    v_cndmask_b32 v184, v22, v184, vcc
    v_cndmask_b32 v185, v22, v185, vcc
    v_cndmask_b32 v186, v22, v186, vcc
    v_cndmask_b32 v187, v22, v187, vcc
    v_max3_f32 v27, v176, v177, v178
    v_max3_f32 v27, v27, v179, v180
    v_max3_f32 v27, v27, v181, v182
    v_max3_f32 v27, v27, v183, v184
    v_max3_f32 v27, v27, v185, v186
    v_max_f32 v27, v27, v187
    ds_bpermute_b32 v28, v20, v27
    s_waitcnt lgkmcnt(0)
    v_max_f32 v27, v27, v28
    ds_bpermute_b32 v28, v21, v27
    s_waitcnt lgkmcnt(0)
    v_max_f32 v27, v27, v28
    v_mov_b32 v28, 0
    v_sub_f32 v176, v176, v27
    v_mul_f32 v176, s28, v176
    v_exp_f32 v176, v176
    s_nop 0
    v_add_f32 v28, v28, v176
    v_sub_f32 v177, v177, v27
    v_mul_f32 v177, s28, v177
    v_exp_f32 v177, v177
    s_nop 0
    v_add_f32 v28, v28, v177
    v_sub_f32 v178, v178, v27
    v_mul_f32 v178, s28, v178
    v_exp_f32 v178, v178
    s_nop 0
    v_add_f32 v28, v28, v178
    v_sub_f32 v179, v179, v27
    v_mul_f32 v179, s28, v179
    v_exp_f32 v179, v179
    s_nop 0
    v_add_f32 v28, v28, v179
    v_sub_f32 v180, v180, v27
    v_mul_f32 v180, s28, v180
    v_exp_f32 v180, v180
    s_nop 0
    v_add_f32 v28, v28, v180
    v_sub_f32 v181, v181, v27
    v_mul_f32 v181, s28, v181
    v_exp_f32 v181, v181
    s_nop 0
    v_add_f32 v28, v28, v181
    v_sub_f32 v182, v182, v27
    v_mul_f32 v182, s28, v182
    v_exp_f32 v182, v182
    s_nop 0
    v_add_f32 v28, v28, v182
    v_sub_f32 v183, v183, v27
    v_mul_f32 v183, s28, v183
    v_exp_f32 v183, v183
    s_nop 0
    v_add_f32 v28, v28, v183
    v_sub_f32 v184, v184, v27
    v_mul_f32 v184, s28, v184
    v_exp_f32 v184, v184
    s_nop 0
    v_add_f32 v28, v28, v184
    v_sub_f32 v185, v185, v27
    v_mul_f32 v185, s28, v185
    v_exp_f32 v185, v185
    s_nop 0
    v_add_f32 v28, v28, v185
    v_sub_f32 v186, v186, v27
    v_mul_f32 v186, s28, v186
    v_exp_f32 v186, v186
    s_nop 0
    v_add_f32 v28, v28, v186
    v_sub_f32 v187, v187, v27
    v_mul_f32 v187, s28, v187
    v_exp_f32 v187, v187
    s_nop 0
    v_add_f32 v28, v28, v187
    ds_bpermute_b32 v29, v20, v28
    s_waitcnt lgkmcnt(0)
    v_add_f32 v28, v28, v29
    ds_bpermute_b32 v29, v21, v28
    s_waitcnt lgkmcnt(0)
    v_add_f32 v28, v28, v29
    v_rcp_f32 v28, v28
    s_nop 0
    v_mul_f32 v176, v176, v28
    v_mul_f32 v177, v177, v28
    v_mul_f32 v178, v178, v28
    v_mul_f32 v179, v179, v28
    v_mul_f32 v180, v180, v28
    v_mul_f32 v181, v181, v28
    v_mul_f32 v182, v182, v28
    v_mul_f32 v183, v183, v28
    v_mul_f32 v184, v184, v28
    v_mul_f32 v185, v185, v28
    v_mul_f32 v186, v186, v28
    v_mul_f32 v187, v187, v28
    v_cvt_pk_bf16_f32 v200, v176, v177
    v_cvt_pk_bf16_f32 v201, v178, v179
    v_cvt_pk_bf16_f32 v202, v180, v181
    v_cvt_pk_bf16_f32 v203, v182, v183
    v_cvt_pk_bf16_f32 v204, v184, v185
    v_cvt_pk_bf16_f32 v205, v186, v187
    v_mov_b32 v206, 0
    v_mov_b32 v207, 0
    v_mov_b32 v32, 0
    v_mov_b32 v33, 0
    v_mov_b32 v34, 0
    v_mov_b32 v35, 0
    v_mov_b32 v36, 0
    v_mov_b32 v37, 0
    v_mov_b32 v38, 0
    v_mov_b32 v39, 0
    v_mov_b32 v40, 0
    v_mov_b32 v41, 0
    v_mov_b32 v42, 0
    v_mov_b32 v43, 0
    v_mov_b32 v44, 0
    v_mov_b32 v45, 0
    v_mov_b32 v46, 0
    v_mov_b32 v47, 0
    v_mov_b32 v48, 0
    v_mov_b32 v49, 0
    v_mov_b32 v50, 0
    v_mov_b32 v51, 0
    v_mov_b32 v52, 0
    v_mov_b32 v53, 0
    v_mov_b32 v54, 0
    v_mov_b32 v55, 0
    v_mov_b32 v56, 0
    v_mov_b32 v57, 0
    v_mov_b32 v58, 0
    v_mov_b32 v59, 0
    v_mov_b32 v60, 0
    v_mov_b32 v61, 0
    v_mov_b32 v62, 0
    v_mov_b32 v63, 0
    s_nop 1
    v_mfma_f32_16x16x32_bf16 v[32:35], v[112:115], v[200:203], v[32:35]
    v_mfma_f32_16x16x32_bf16 v[36:39], v[116:119], v[200:203], v[36:39]
    v_mfma_f32_16x16x32_bf16 v[40:43], v[120:123], v[200:203], v[40:43]
    v_mfma_f32_16x16x32_bf16 v[44:47], v[124:127], v[200:203], v[44:47]
    v_mfma_f32_16x16x32_bf16 v[48:51], v[128:131], v[200:203], v[48:51]
    v_mfma_f32_16x16x32_bf16 v[52:55], v[132:135], v[200:203], v[52:55]
    v_mfma_f32_16x16x32_bf16 v[56:59], v[136:139], v[200:203], v[56:59]
    v_mfma_f32_16x16x32_bf16 v[60:63], v[140:143], v[200:203], v[60:63]
    v_mfma_f32_16x16x32_bf16 v[32:35], v[144:147], v[204:207], v[32:35]
    v_mfma_f32_16x16x32_bf16 v[36:39], v[148:151], v[204:207], v[36:39]
    v_mfma_f32_16x16x32_bf16 v[40:43], v[152:155], v[204:207], v[40:43]
    v_mfma_f32_16x16x32_bf16 v[44:47], v[156:159], v[204:207], v[44:47]
    v_mfma_f32_16x16x32_bf16 v[48:51], v[160:163], v[204:207], v[48:51]
    v_mfma_f32_16x16x32_bf16 v[52:55], v[164:167], v[204:207], v[52:55]
    v_mfma_f32_16x16x32_bf16 v[56:59], v[168:171], v[204:207], v[56:59]
    v_mfma_f32_16x16x32_bf16 v[60:63], v[172:175], v[204:207], v[60:63]
    s_nop 7
    s_nop 1
    v_cvt_pk_bf16_f32 v208, v32, v33
    v_cvt_pk_bf16_f32 v209, v34, v35
    buffer_store_dwordx2 v[208:209], v23, s[8:11], s29 offen offset:0 sc1
    v_cvt_pk_bf16_f32 v210, v36, v37
    v_cvt_pk_bf16_f32 v211, v38, v39
    buffer_store_dwordx2 v[210:211], v23, s[8:11], s29 offen offset:32 sc1
    v_cvt_pk_bf16_f32 v212, v40, v41
    v_cvt_pk_bf16_f32 v213, v42, v43
    buffer_store_dwordx2 v[212:213], v23, s[8:11], s29 offen offset:64 sc1
    v_cvt_pk_bf16_f32 v214, v44, v45
    v_cvt_pk_bf16_f32 v215, v46, v47
    buffer_store_dwordx2 v[214:215], v23, s[8:11], s29 offen offset:96 sc1
    v_cvt_pk_bf16_f32 v216, v48, v49
    v_cvt_pk_bf16_f32 v217, v50, v51
    buffer_store_dwordx2 v[216:217], v23, s[8:11], s29 offen offset:128 sc1
    v_cvt_pk_bf16_f32 v218, v52, v53
    v_cvt_pk_bf16_f32 v219, v54, v55
    buffer_store_dwordx2 v[218:219], v23, s[8:11], s29 offen offset:160 sc1
    v_cvt_pk_bf16_f32 v220, v56, v57
    v_cvt_pk_bf16_f32 v221, v58, v59
    buffer_store_dwordx2 v[220:221], v23, s[8:11], s29 offen offset:192 sc1
    v_cvt_pk_bf16_f32 v222, v60, v61
    v_cvt_pk_bf16_f32 v223, v62, v63
    buffer_store_dwordx2 v[222:223], v23, s[8:11], s29 offen offset:224 sc1
    s_add_u32 s29, s29, 0x20000
    s_nop 1
    v_cvt_pk_bf16_f32 v188, v188, v188
    v_lshlrev_b32 v188, 16, v188
    v_mul_f32 v188, s27, v188
    v_cvt_pk_bf16_f32 v188, v188, v188
    v_lshlrev_b32 v188, 16, v188
    v_cvt_pk_bf16_f32 v189, v189, v189
    v_lshlrev_b32 v189, 16, v189
    v_mul_f32 v189, s27, v189
    v_cvt_pk_bf16_f32 v189, v189, v189
    v_lshlrev_b32 v189, 16, v189
    v_cvt_pk_bf16_f32 v190, v190, v190
    v_lshlrev_b32 v190, 16, v190
    v_mul_f32 v190, s27, v190
    v_cvt_pk_bf16_f32 v190, v190, v190
    v_lshlrev_b32 v190, 16, v190
    v_cvt_pk_bf16_f32 v191, v191, v191
    v_lshlrev_b32 v191, 16, v191
    v_mul_f32 v191, s27, v191
    v_cvt_pk_bf16_f32 v191, v191, v191
    v_lshlrev_b32 v191, 16, v191
    v_cvt_pk_bf16_f32 v192, v192, v192
    v_lshlrev_b32 v192, 16, v192
    v_mul_f32 v192, s27, v192
    v_cvt_pk_bf16_f32 v192, v192, v192
    v_lshlrev_b32 v192, 16, v192
    v_cvt_pk_bf16_f32 v193, v193, v193
    v_lshlrev_b32 v193, 16, v193
    v_mul_f32 v193, s27, v193
    v_cvt_pk_bf16_f32 v193, v193, v193
    v_lshlrev_b32 v193, 16, v193
    v_cvt_pk_bf16_f32 v194, v194, v194
    v_lshlrev_b32 v194, 16, v194
    v_mul_f32 v194, s27, v194
    v_cvt_pk_bf16_f32 v194, v194, v194
    v_lshlrev_b32 v194, 16, v194
    v_cvt_pk_bf16_f32 v195, v195, v195
    v_lshlrev_b32 v195, 16, v195
    v_mul_f32 v195, s27, v195
    v_cvt_pk_bf16_f32 v195, v195, v195
    v_lshlrev_b32 v195, 16, v195
    v_cvt_pk_bf16_f32 v196, v196, v196
    v_lshlrev_b32 v196, 16, v196
    v_mul_f32 v196, s27, v196
    v_cvt_pk_bf16_f32 v196, v196, v196
    v_lshlrev_b32 v196, 16, v196
    v_cvt_pk_bf16_f32 v197, v197, v197
    v_lshlrev_b32 v197, 16, v197
    v_mul_f32 v197, s27, v197
    v_cvt_pk_bf16_f32 v197, v197, v197
    v_lshlrev_b32 v197, 16, v197
    v_cvt_pk_bf16_f32 v198, v198, v198
    v_lshlrev_b32 v198, 16, v198
    v_mul_f32 v198, s27, v198
    v_cvt_pk_bf16_f32 v198, v198, v198
    v_lshlrev_b32 v198, 16, v198
    v_cvt_pk_bf16_f32 v199, v199, v199
    v_lshlrev_b32 v199, 16, v199
    v_mul_f32 v199, s27, v199
    v_cvt_pk_bf16_f32 v199, v199, v199
    v_lshlrev_b32 v199, 16, v199
    v_lshlrev_b32 v24, 2, v4
    v_subrev_u32 v25, 16, v24
    v_cmp_le_i32 vcc, v25, v3
    s_nop 1
    v_cndmask_b32 v188, v22, v188, vcc
    v_subrev_u32 v25, 15, v24
    v_cmp_le_i32 vcc, v25, v3
    s_nop 1
    v_cndmask_b32 v189, v22, v189, vcc
    v_subrev_u32 v25, 14, v24
    v_cmp_le_i32 vcc, v25, v3
    s_nop 1
    v_cndmask_b32 v190, v22, v190, vcc
    v_subrev_u32 v25, 13, v24
    v_cmp_le_i32 vcc, v25, v3
    s_nop 1
    v_cndmask_b32 v191, v22, v191, vcc
    v_add_u32 v25, 0, v24
    v_cmp_le_i32 vcc, v25, v3
    s_nop 1
    v_cndmask_b32 v192, v22, v192, vcc
    v_add_u32 v25, 1, v24
    v_cmp_le_i32 vcc, v25, v3
    s_nop 1
    v_cndmask_b32 v193, v22, v193, vcc
    v_add_u32 v25, 2, v24
    v_cmp_le_i32 vcc, v25, v3
    s_nop 1
    v_cndmask_b32 v194, v22, v194, vcc
    v_add_u32 v25, 3, v24
    v_cmp_le_i32 vcc, v25, v3
    s_nop 1
    v_cndmask_b32 v195, v22, v195, vcc
    v_cmp_gt_u32 vcc, 2, v4
    s_nop 1
    v_cndmask_b32 v196, v22, v196, vcc
    v_cndmask_b32 v197, v22, v197, vcc
    v_cndmask_b32 v198, v22, v198, vcc
    v_cndmask_b32 v199, v22, v199, vcc
    v_max3_f32 v27, v188, v189, v190
    v_max3_f32 v27, v27, v191, v192
    v_max3_f32 v27, v27, v193, v194
    v_max3_f32 v27, v27, v195, v196
    v_max3_f32 v27, v27, v197, v198
    v_max_f32 v27, v27, v199
    ds_bpermute_b32 v28, v20, v27
    s_waitcnt lgkmcnt(0)
    v_max_f32 v27, v27, v28
    ds_bpermute_b32 v28, v21, v27
    s_waitcnt lgkmcnt(0)
    v_max_f32 v27, v27, v28
    v_mov_b32 v28, 0
    v_sub_f32 v188, v188, v27
    v_mul_f32 v188, s28, v188
    v_exp_f32 v188, v188
    s_nop 0
    v_add_f32 v28, v28, v188
    v_sub_f32 v189, v189, v27
    v_mul_f32 v189, s28, v189
    v_exp_f32 v189, v189
    s_nop 0
    v_add_f32 v28, v28, v189
    v_sub_f32 v190, v190, v27
    v_mul_f32 v190, s28, v190
    v_exp_f32 v190, v190
    s_nop 0
    v_add_f32 v28, v28, v190
    v_sub_f32 v191, v191, v27
    v_mul_f32 v191, s28, v191
    v_exp_f32 v191, v191
    s_nop 0
    v_add_f32 v28, v28, v191
    v_sub_f32 v192, v192, v27
    v_mul_f32 v192, s28, v192
    v_exp_f32 v192, v192
    s_nop 0
    v_add_f32 v28, v28, v192
    v_sub_f32 v193, v193, v27
    v_mul_f32 v193, s28, v193
    v_exp_f32 v193, v193
    s_nop 0
    v_add_f32 v28, v28, v193
    v_sub_f32 v194, v194, v27
    v_mul_f32 v194, s28, v194
    v_exp_f32 v194, v194
    s_nop 0
    v_add_f32 v28, v28, v194
    v_sub_f32 v195, v195, v27
    v_mul_f32 v195, s28, v195
    v_exp_f32 v195, v195
    s_nop 0
    v_add_f32 v28, v28, v195
    v_sub_f32 v196, v196, v27
    v_mul_f32 v196, s28, v196
    v_exp_f32 v196, v196
    s_nop 0
    v_add_f32 v28, v28, v196
    v_sub_f32 v197, v197, v27
    v_mul_f32 v197, s28, v197
    v_exp_f32 v197, v197
    s_nop 0
    v_add_f32 v28, v28, v197
    v_sub_f32 v198, v198, v27
    v_mul_f32 v198, s28, v198
    v_exp_f32 v198, v198
    s_nop 0
    v_add_f32 v28, v28, v198
    v_sub_f32 v199, v199, v27
    v_mul_f32 v199, s28, v199
    v_exp_f32 v199, v199
    s_nop 0
    v_add_f32 v28, v28, v199
    ds_bpermute_b32 v29, v20, v28
    s_waitcnt lgkmcnt(0)
    v_add_f32 v28, v28, v29
    ds_bpermute_b32 v29, v21, v28
    s_waitcnt lgkmcnt(0)
    v_add_f32 v28, v28, v29
    v_rcp_f32 v28, v28
    s_nop 0
    v_mul_f32 v188, v188, v28
    v_mul_f32 v189, v189, v28
    v_mul_f32 v190, v190, v28
    v_mul_f32 v191, v191, v28
    v_mul_f32 v192, v192, v28
    v_mul_f32 v193, v193, v28
    v_mul_f32 v194, v194, v28
    v_mul_f32 v195, v195, v28
    v_mul_f32 v196, v196, v28
    v_mul_f32 v197, v197, v28
    v_mul_f32 v198, v198, v28
    v_mul_f32 v199, v199, v28
    v_cvt_pk_bf16_f32 v200, v188, v189
    v_cvt_pk_bf16_f32 v201, v190, v191
    v_cvt_pk_bf16_f32 v202, v192, v193
    v_cvt_pk_bf16_f32 v203, v194, v195
    v_cvt_pk_bf16_f32 v204, v196, v197
    v_cvt_pk_bf16_f32 v205, v198, v199
    v_mov_b32 v206, 0
    v_mov_b32 v207, 0
    v_mov_b32 v32, 0
    v_mov_b32 v33, 0
    v_mov_b32 v34, 0
    v_mov_b32 v35, 0
    v_mov_b32 v36, 0
    v_mov_b32 v37, 0
    v_mov_b32 v38, 0
    v_mov_b32 v39, 0
    v_mov_b32 v40, 0
    v_mov_b32 v41, 0
    v_mov_b32 v42, 0
    v_mov_b32 v43, 0
    v_mov_b32 v44, 0
    v_mov_b32 v45, 0
    v_mov_b32 v46, 0
    v_mov_b32 v47, 0
    v_mov_b32 v48, 0
    v_mov_b32 v49, 0
    v_mov_b32 v50, 0
    v_mov_b32 v51, 0
    v_mov_b32 v52, 0
    v_mov_b32 v53, 0
    v_mov_b32 v54, 0
    v_mov_b32 v55, 0
    v_mov_b32 v56, 0
    v_mov_b32 v57, 0
    v_mov_b32 v58, 0
    v_mov_b32 v59, 0
    v_mov_b32 v60, 0
    v_mov_b32 v61, 0
    v_mov_b32 v62, 0
    v_mov_b32 v63, 0
    s_nop 1
    v_mfma_f32_16x16x32_bf16 v[32:35], v[112:115], v[200:203], v[32:35]
    v_mfma_f32_16x16x32_bf16 v[36:39], v[116:119], v[200:203], v[36:39]
    v_mfma_f32_16x16x32_bf16 v[40:43], v[120:123], v[200:203], v[40:43]
    v_mfma_f32_16x16x32_bf16 v[44:47], v[124:127], v[200:203], v[44:47]
    v_mfma_f32_16x16x32_bf16 v[48:51], v[128:131], v[200:203], v[48:51]
    v_mfma_f32_16x16x32_bf16 v[52:55], v[132:135], v[200:203], v[52:55]
    v_mfma_f32_16x16x32_bf16 v[56:59], v[136:139], v[200:203], v[56:59]
    v_mfma_f32_16x16x32_bf16 v[60:63], v[140:143], v[200:203], v[60:63]
    v_mfma_f32_16x16x32_bf16 v[32:35], v[144:147], v[204:207], v[32:35]
    v_mfma_f32_16x16x32_bf16 v[36:39], v[148:151], v[204:207], v[36:39]
    v_mfma_f32_16x16x32_bf16 v[40:43], v[152:155], v[204:207], v[40:43]
    v_mfma_f32_16x16x32_bf16 v[44:47], v[156:159], v[204:207], v[44:47]
    v_mfma_f32_16x16x32_bf16 v[48:51], v[160:163], v[204:207], v[48:51]
    v_mfma_f32_16x16x32_bf16 v[52:55], v[164:167], v[204:207], v[52:55]
    v_mfma_f32_16x16x32_bf16 v[56:59], v[168:171], v[204:207], v[56:59]
    v_mfma_f32_16x16x32_bf16 v[60:63], v[172:175], v[204:207], v[60:63]
    s_nop 7
    s_nop 1
    v_cvt_pk_bf16_f32 v208, v32, v33
    v_cvt_pk_bf16_f32 v209, v34, v35
    buffer_store_dwordx2 v[208:209], v23, s[8:11], s29 offen offset:0 sc1
    v_cvt_pk_bf16_f32 v210, v36, v37
    v_cvt_pk_bf16_f32 v211, v38, v39
    buffer_store_dwordx2 v[210:211], v23, s[8:11], s29 offen offset:32 sc1
    v_cvt_pk_bf16_f32 v212, v40, v41
    v_cvt_pk_bf16_f32 v213, v42, v43
    buffer_store_dwordx2 v[212:213], v23, s[8:11], s29 offen offset:64 sc1
    v_cvt_pk_bf16_f32 v214, v44, v45
    v_cvt_pk_bf16_f32 v215, v46, v47
    buffer_store_dwordx2 v[214:215], v23, s[8:11], s29 offen offset:96 sc1
    v_cvt_pk_bf16_f32 v216, v48, v49
    v_cvt_pk_bf16_f32 v217, v50, v51
    buffer_store_dwordx2 v[216:217], v23, s[8:11], s29 offen offset:128 sc1
    v_cvt_pk_bf16_f32 v218, v52, v53
    v_cvt_pk_bf16_f32 v219, v54, v55
    buffer_store_dwordx2 v[218:219], v23, s[8:11], s29 offen offset:160 sc1
    v_cvt_pk_bf16_f32 v220, v56, v57
    v_cvt_pk_bf16_f32 v221, v58, v59
    buffer_store_dwordx2 v[220:221], v23, s[8:11], s29 offen offset:192 sc1
    v_cvt_pk_bf16_f32 v222, v60, v61
    v_cvt_pk_bf16_f32 v223, v62, v63
    buffer_store_dwordx2 v[222:223], v23, s[8:11], s29 offen offset:224 sc1
    s_add_u32 s29, s29, 0x20000
    s_nop 1
    s_add_u32 s58, s58, 4
    s_cmp_lt_u32 s58, 8
    s_cbranch_scc1 wk_at_loop
    s_lshr_b32 s7, s60, 3
    s_lshl_b32 s7, s7, 2
    s_add_u32 s7, s7, 256
    s_waitcnt vmcnt(0)
    s_barrier
    v_mov_b32 v1, 1
    s_add_u32 s5, s7, 117440512
    v_mov_b32 v2, s5
    v_cmp_eq_u32 vcc, 0, v0
    s_and_saveexec_b64 s[46:47], vcc
    buffer_atomic_add v1, v2, s[8:11], 0 offen sc1
    s_mov_b64 exec, s[46:47]
    s_branch wk_p4n
wk_tile:
    s_lshr_b32 s3, s60, 4
    s_lshl_b32 s4, s74, 3
    s_add_u32 s3, s3, s4
    s_lshr_b32 s4, s60, 1
    s_and_b32 s4, s4, 7
    s_lshl_b32 s7, s3, 2
    s_add_u32 s7, s7, 256
    s_add_u32 s5, s7, 117440512
    v_mov_b32 v2, s5
    s_mov_b32 s6, 0
    v_lshrrev_b32 v1, 6, v0
    s_nop 1
    v_readfirstlane_b32 s75, v1
    s_nop 3
    s_cmp_lg_u32 s75, 0
    s_cbranch_scc1 wk_g_13
wk_w_12:
    buffer_load_dword v1, v2, s[8:11], 0 offen sc1
    s_waitcnt vmcnt(0)
    v_cmp_le_u32 vcc, 8, v1
    s_cbranch_vccnz wk_g_13
    s_sleep 48
    s_add_u32 s6, s6, 1
    s_cmp_lt_u32 s6, 0x80000
    s_cbranch_scc1 wk_w_12
wk_g_13:
    s_barrier
    s_lshr_b32 s7, s3, 1
    s_lshl_b32 s7, s7, 2
    s_add_u32 s7, s7, 192
    s_add_u32 s5, s7, 117440512
    v_mov_b32 v2, s5
    s_mov_b32 s6, 0
    v_lshrrev_b32 v1, 6, v0
    s_nop 1
    v_readfirstlane_b32 s75, v1
    s_nop 3
    s_cmp_lg_u32 s75, 0
    s_cbranch_scc1 wk_g_15
wk_w_14:
    buffer_load_dword v1, v2, s[8:11], 0 offen sc1
    s_waitcnt vmcnt(0)
    v_cmp_le_u32 vcc, 8, v1
    s_cbranch_vccnz wk_g_15
    s_sleep 48
    s_add_u32 s6, s6, 1
    s_cmp_lt_u32 s6, 0x80000
    s_cbranch_scc1 wk_w_14
wk_g_15:
    s_barrier
    s_barrier
    s_load_dwordx2 s[16:17], s[0:1], 40
    s_load_dwordx4 s[20:23], s[0:1], 80
    s_load_dwordx2 s[24:25], s[0:1], 0
    s_load_dwordx2 s[26:27], s[0:1], 96
    s_load_dwordx2 s[28:29], s[0:1], 112
    v_and_b32 v6, 63, v0
    v_lshrrev_b32 v7, 6, v0
    v_lshrrev_b32 v1, 3, v0
    v_mul_u32_u24 v2, 144, v1
    v_and_b32 v1, 7, v0
    v_lshlrev_b32 v1, 4, v1
    v_add_u32 v2, v2, v1
    v_lshrrev_b32 v1, 4, v0
    v_mul_u32_u24 v3, 320, v1
    v_and_b32 v1, 15, v0
    v_lshlrev_b32 v1, 4, v1
    v_add_u32 v3, v3, v1
    v_add_u32 v3, 9216, v3
    v_lshrrev_b32 v1, 1, v7
    v_lshlrev_b32 v1, 5, v1
    v_and_b32 v8, 31, v6
    v_add_u32 v1, v1, v8
    v_mul_u32_u24 v4, 144, v1
    v_lshrrev_b32 v1, 5, v6
    v_lshlrev_b32 v1, 4, v1
    v_add_u32 v4, v4, v1
    v_lshrrev_b32 v1, 5, v6
    v_lshlrev_b32 v1, 3, v1
    v_and_b32 v8, 15, v6
    v_lshrrev_b32 v8, 2, v8
    v_add_u32 v1, v1, v8
    v_mul_u32_u24 v5, 320, v1
    v_and_b32 v1, 1, v7
    v_lshlrev_b32 v1, 7, v1
    v_bfe_u32 v8, v6, 4, 1
    v_lshlrev_b32 v8, 5, v8
    v_add_u32 v1, v1, v8
    v_and_b32 v8, 3, v6
    v_lshlrev_b32 v8, 3, v8
    v_add3_u32 v5, v5, v1, v8
    v_add_u32 v5, 9216, v5
    v_add_u32 v2, s57, v2
    v_add_u32 v3, s57, v3
    v_add_u32 v4, s57, v4
    v_add_u32 v5, s57, v5
    s_waitcnt lgkmcnt(0)
    s_mov_b32 s8, s28
    s_mov_b32 s9, s29
    s_mov_b32 s10, 268435456
    s_mov_b32 s11, 0x00020000
    v_lshrrev_b32 v1, 4, v0
    v_lshlrev_b32 v11, 11, v1
    v_and_b32 v1, 15, v0
    v_lshlrev_b32 v1, 4, v1
    s_lshl_b32 s34, s4, 8
    v_add3_u32 v11, v11, v1, s34
    s_mov_b32 s12, s16
    s_mov_b32 s13, s17
    s_mov_b32 s14, 8388608
    s_mov_b32 s15, 0x00020000
    v_lshrrev_b32 v1, 3, v0
    s_lshl_b32 s34, s3, 6
    v_add_u32 v1, s34, v1
    v_lshlrev_b32 v10, 13, v1
    v_and_b32 v1, 7, v0
    v_lshlrev_b32 v1, 4, v1
    v_add_u32 v10, v10, v1
    s_lshl_b32 s37, s59, 12
    s_lshl_b32 s38, s59, 22
    s_add_u32 s48, s37, 75497472
    s_add_u32 s49, s37, 75759616
    s_add_u32 s52, s38, 0
    s_add_u32 s53, s38, 32768
    s_add_u32 s54, s38, 65536
    s_add_u32 s55, s38, 98304
    v_mov_b32 v80, 0
    v_mov_b32 v81, 0
    v_mov_b32 v82, 0
    v_mov_b32 v83, 0
    v_mov_b32 v84, 0
    v_mov_b32 v85, 0
    v_mov_b32 v86, 0
    v_mov_b32 v87, 0
    v_mov_b32 v88, 0
    v_mov_b32 v89, 0
    v_mov_b32 v90, 0
    v_mov_b32 v91, 0
    v_mov_b32 v92, 0
    v_mov_b32 v93, 0
    v_mov_b32 v94, 0
    v_mov_b32 v95, 0
    v_mov_b32 v96, 0
    v_mov_b32 v97, 0
    v_mov_b32 v98, 0
    v_mov_b32 v99, 0
    v_mov_b32 v100, 0
    v_mov_b32 v101, 0
    v_mov_b32 v102, 0
    v_mov_b32 v103, 0
    v_mov_b32 v104, 0
    v_mov_b32 v105, 0
    v_mov_b32 v106, 0
    v_mov_b32 v107, 0
    v_mov_b32 v108, 0
    v_mov_b32 v109, 0
    v_mov_b32 v110, 0
    v_mov_b32 v111, 0
    buffer_load_dwordx4 v[16:19], v10, s[8:11], s48 offen sc1
    buffer_load_dwordx4 v[20:23], v10, s[8:11], s49 offen sc1
    buffer_load_dwordx4 v[32:35], v11, s[12:15], s52 offen
    buffer_load_dwordx4 v[36:39], v11, s[12:15], s53 offen
    buffer_load_dwordx4 v[40:43], v11, s[12:15], s54 offen
    buffer_load_dwordx4 v[44:47], v11, s[12:15], s55 offen
    s_add_u32 s48, s48, 128
    s_add_u32 s49, s49, 128
    s_add_u32 s52, s52, 131072
    s_add_u32 s53, s53, 131072
    s_add_u32 s54, s54, 131072
    s_add_u32 s55, s55, 131072
    buffer_load_dwordx4 v[176:179], v10, s[8:11], s48 offen sc1
    buffer_load_dwordx4 v[180:183], v10, s[8:11], s49 offen sc1
    buffer_load_dwordx4 v[192:195], v11, s[12:15], s52 offen
    buffer_load_dwordx4 v[196:199], v11, s[12:15], s53 offen
    buffer_load_dwordx4 v[200:203], v11, s[12:15], s54 offen
    buffer_load_dwordx4 v[204:207], v11, s[12:15], s55 offen
    s_add_u32 s48, s48, 128
    s_add_u32 s49, s49, 128
    s_add_u32 s52, s52, 131072
    s_add_u32 s53, s53, 131072
    s_add_u32 s54, s54, 131072
    s_add_u32 s55, s55, 131072
    s_waitcnt vmcnt(6)
    ds_write_b128 v2, v[16:19] offset:0
    ds_write_b128 v2, v[20:23] offset:4608
    ds_write_b128 v3, v[32:35] offset:0
    ds_write_b128 v3, v[36:39] offset:5120
    ds_write_b128 v3, v[40:43] offset:10240
    ds_write_b128 v3, v[44:47] offset:15360
    s_waitcnt lgkmcnt(0)
    s_barrier
    s_mov_b32 s36, 16
g2loop_16:
    buffer_load_dwordx4 v[16:19], v10, s[8:11], s48 offen sc1
    buffer_load_dwordx4 v[20:23], v10, s[8:11], s49 offen sc1
    buffer_load_dwordx4 v[32:35], v11, s[12:15], s52 offen
    buffer_load_dwordx4 v[36:39], v11, s[12:15], s53 offen
    buffer_load_dwordx4 v[40:43], v11, s[12:15], s54 offen
    buffer_load_dwordx4 v[44:47], v11, s[12:15], s55 offen
    s_add_u32 s48, s48, 128
    s_add_u32 s49, s49, 128
    s_add_u32 s52, s52, 131072
    s_add_u32 s53, s53, 131072
    s_add_u32 s54, s54, 131072
    s_add_u32 s55, s55, 131072
    ds_read_b128 v[48:51], v4 offset:0
    ds_read_b64_tr_b16 v[56:57], v5 offset:0
    ds_read_b64_tr_b16 v[58:59], v5 offset:1280
    ds_read_b64_tr_b16 v[60:61], v5 offset:64
    ds_read_b64_tr_b16 v[62:63], v5 offset:1344
    ds_read_b128 v[64:67], v4 offset:32
    ds_read_b64_tr_b16 v[72:73], v5 offset:5120
    ds_read_b64_tr_b16 v[74:75], v5 offset:6400
    ds_read_b64_tr_b16 v[76:77], v5 offset:5184
    ds_read_b64_tr_b16 v[78:79], v5 offset:6464
    s_waitcnt lgkmcnt(5)
    v_mfma_f32_32x32x16_bf16 v[80:95], v[56:59], v[48:51], v[80:95]
    v_mfma_f32_32x32x16_bf16 v[96:111], v[60:63], v[48:51], v[96:111]
    ds_read_b128 v[48:51], v4 offset:64
    ds_read_b64_tr_b16 v[56:57], v5 offset:10240
    ds_read_b64_tr_b16 v[58:59], v5 offset:11520
    ds_read_b64_tr_b16 v[60:61], v5 offset:10304
    ds_read_b64_tr_b16 v[62:63], v5 offset:11584
    s_waitcnt lgkmcnt(5)
    v_mfma_f32_32x32x16_bf16 v[80:95], v[72:75], v[64:67], v[80:95]
    v_mfma_f32_32x32x16_bf16 v[96:111], v[76:79], v[64:67], v[96:111]
    ds_read_b128 v[64:67], v4 offset:96
    ds_read_b64_tr_b16 v[72:73], v5 offset:15360
    ds_read_b64_tr_b16 v[74:75], v5 offset:16640
    ds_read_b64_tr_b16 v[76:77], v5 offset:15424
    ds_read_b64_tr_b16 v[78:79], v5 offset:16704
    s_waitcnt lgkmcnt(5)
    v_mfma_f32_32x32x16_bf16 v[80:95], v[56:59], v[48:51], v[80:95]
    v_mfma_f32_32x32x16_bf16 v[96:111], v[60:63], v[48:51], v[96:111]
    s_waitcnt lgkmcnt(0)
    v_mfma_f32_32x32x16_bf16 v[80:95], v[72:75], v[64:67], v[80:95]
    v_mfma_f32_32x32x16_bf16 v[96:111], v[76:79], v[64:67], v[96:111]
    s_waitcnt vmcnt(6)
    ds_write_b128 v2, v[176:179] offset:29696
    ds_write_b128 v2, v[180:183] offset:34304
    ds_write_b128 v3, v[192:195] offset:29696
    ds_write_b128 v3, v[196:199] offset:34816
    ds_write_b128 v3, v[200:203] offset:39936
    ds_write_b128 v3, v[204:207] offset:45056
    s_waitcnt lgkmcnt(0)
    s_barrier
    buffer_load_dwordx4 v[176:179], v10, s[8:11], s48 offen sc1
    buffer_load_dwordx4 v[180:183], v10, s[8:11], s49 offen sc1
    buffer_load_dwordx4 v[192:195], v11, s[12:15], s52 offen
    buffer_load_dwordx4 v[196:199], v11, s[12:15], s53 offen
    buffer_load_dwordx4 v[200:203], v11, s[12:15], s54 offen
    buffer_load_dwordx4 v[204:207], v11, s[12:15], s55 offen
    s_add_u32 s48, s48, 128
    s_add_u32 s49, s49, 128
    s_add_u32 s52, s52, 131072
    s_add_u32 s53, s53, 131072
    s_add_u32 s54, s54, 131072
    s_add_u32 s55, s55, 131072
    ds_read_b128 v[48:51], v4 offset:29696
    ds_read_b64_tr_b16 v[56:57], v5 offset:29696
    ds_read_b64_tr_b16 v[58:59], v5 offset:30976
    ds_read_b64_tr_b16 v[60:61], v5 offset:29760
    ds_read_b64_tr_b16 v[62:63], v5 offset:31040
    ds_read_b128 v[64:67], v4 offset:29728
    ds_read_b64_tr_b16 v[72:73], v5 offset:34816
    ds_read_b64_tr_b16 v[74:75], v5 offset:36096
    ds_read_b64_tr_b16 v[76:77], v5 offset:34880
    ds_read_b64_tr_b16 v[78:79], v5 offset:36160
    s_waitcnt lgkmcnt(5)
    v_mfma_f32_32x32x16_bf16 v[80:95], v[56:59], v[48:51], v[80:95]
    v_mfma_f32_32x32x16_bf16 v[96:111], v[60:63], v[48:51], v[96:111]
    ds_read_b128 v[48:51], v4 offset:29760
    ds_read_b64_tr_b16 v[56:57], v5 offset:39936
    ds_read_b64_tr_b16 v[58:59], v5 offset:41216
    ds_read_b64_tr_b16 v[60:61], v5 offset:40000
    ds_read_b64_tr_b16 v[62:63], v5 offset:41280
    s_waitcnt lgkmcnt(5)
    v_mfma_f32_32x32x16_bf16 v[80:95], v[72:75], v[64:67], v[80:95]
    v_mfma_f32_32x32x16_bf16 v[96:111], v[76:79], v[64:67], v[96:111]
    ds_read_b128 v[64:67], v4 offset:29792
    ds_read_b64_tr_b16 v[72:73], v5 offset:45056
    ds_read_b64_tr_b16 v[74:75], v5 offset:46336
    ds_read_b64_tr_b16 v[76:77], v5 offset:45120
    ds_read_b64_tr_b16 v[78:79], v5 offset:46400
    s_waitcnt lgkmcnt(5)
    v_mfma_f32_32x32x16_bf16 v[80:95], v[56:59], v[48:51], v[80:95]
    v_mfma_f32_32x32x16_bf16 v[96:111], v[60:63], v[48:51], v[96:111]
    s_waitcnt lgkmcnt(0)
    v_mfma_f32_32x32x16_bf16 v[80:95], v[72:75], v[64:67], v[80:95]
    v_mfma_f32_32x32x16_bf16 v[96:111], v[76:79], v[64:67], v[96:111]
    s_waitcnt vmcnt(6)
    ds_write_b128 v2, v[16:19] offset:0
    ds_write_b128 v2, v[20:23] offset:4608
    ds_write_b128 v3, v[32:35] offset:0
    ds_write_b128 v3, v[36:39] offset:5120
    ds_write_b128 v3, v[40:43] offset:10240
    ds_write_b128 v3, v[44:47] offset:15360
    s_waitcnt lgkmcnt(0)
    s_barrier
    s_sub_u32 s36, s36, 1
    s_cmp_lg_u32 s36, 0
    s_cbranch_scc1 g2loop_16
    s_waitcnt vmcnt(0)
    s_nop 7
    s_nop 7
    v_lshlrev_b32 v1, 4, v0
    s_cmp_eq_u32 s59, 0
    s_cbranch_scc1 op_h0a
    ds_write_b128 v1, v[80:83] offset:0
    ds_write_b128 v1, v[84:87] offset:4096
    ds_write_b128 v1, v[88:91] offset:8192
    ds_write_b128 v1, v[92:95] offset:12288
    ds_write_b128 v1, v[96:99] offset:16384
    ds_write_b128 v1, v[100:103] offset:20480
    ds_write_b128 v1, v[104:107] offset:24576
    ds_write_b128 v1, v[108:111] offset:28672
op_h0a:
    s_waitcnt lgkmcnt(0)
    s_barrier
    s_cmp_lg_u32 s59, 0
    s_cbranch_scc1 op_skip
    ds_read_b128 v[144:147], v1 offset:0
    ds_read_b128 v[148:151], v1 offset:4096
    ds_read_b128 v[152:155], v1 offset:8192
    ds_read_b128 v[156:159], v1 offset:12288
    ds_read_b128 v[160:163], v1 offset:16384
    ds_read_b128 v[164:167], v1 offset:20480
    ds_read_b128 v[168:171], v1 offset:24576
    ds_read_b128 v[172:175], v1 offset:28672
    s_waitcnt lgkmcnt(0)
    v_add_f32 v80, v80, v144
    v_add_f32 v81, v81, v145
    v_add_f32 v82, v82, v146
    v_add_f32 v83, v83, v147
    v_add_f32 v84, v84, v148
    v_add_f32 v85, v85, v149
    v_add_f32 v86, v86, v150
    v_add_f32 v87, v87, v151
    v_add_f32 v88, v88, v152
    v_add_f32 v89, v89, v153
    v_add_f32 v90, v90, v154
    v_add_f32 v91, v91, v155
    v_add_f32 v92, v92, v156
    v_add_f32 v93, v93, v157
    v_add_f32 v94, v94, v158
    v_add_f32 v95, v95, v159
    v_add_f32 v96, v96, v160
    v_add_f32 v97, v97, v161
    v_add_f32 v98, v98, v162
    v_add_f32 v99, v99, v163
    v_add_f32 v100, v100, v164
    v_add_f32 v101, v101, v165
    v_add_f32 v102, v102, v166
    v_add_f32 v103, v103, v167
    v_add_f32 v104, v104, v168
    v_add_f32 v105, v105, v169
    v_add_f32 v106, v106, v170
    v_add_f32 v107, v107, v171
    v_add_f32 v108, v108, v172
    v_add_f32 v109, v109, v173
    v_add_f32 v110, v110, v174
    v_add_f32 v111, v111, v175
    v_cvt_pk_bf16_f32 v144, v80, v80
    v_lshlrev_b32 v144, 16, v144
    v_cvt_pk_bf16_f32 v145, v81, v81
    v_lshlrev_b32 v145, 16, v145
    v_cvt_pk_bf16_f32 v146, v82, v82
    v_lshlrev_b32 v146, 16, v146
    v_cvt_pk_bf16_f32 v147, v83, v83
    v_lshlrev_b32 v147, 16, v147
    v_cvt_pk_bf16_f32 v148, v84, v84
    v_lshlrev_b32 v148, 16, v148
    v_cvt_pk_bf16_f32 v149, v85, v85
    v_lshlrev_b32 v149, 16, v149
    v_cvt_pk_bf16_f32 v150, v86, v86
    v_lshlrev_b32 v150, 16, v150
    v_cvt_pk_bf16_f32 v151, v87, v87
    v_lshlrev_b32 v151, 16, v151
    v_cvt_pk_bf16_f32 v152, v88, v88
    v_lshlrev_b32 v152, 16, v152
    v_cvt_pk_bf16_f32 v153, v89, v89
    v_lshlrev_b32 v153, 16, v153
    v_cvt_pk_bf16_f32 v154, v90, v90
    v_lshlrev_b32 v154, 16, v154
    v_cvt_pk_bf16_f32 v155, v91, v91
    v_lshlrev_b32 v155, 16, v155
    v_cvt_pk_bf16_f32 v156, v92, v92
    v_lshlrev_b32 v156, 16, v156
    v_cvt_pk_bf16_f32 v157, v93, v93
    v_lshlrev_b32 v157, 16, v157
    v_cvt_pk_bf16_f32 v158, v94, v94
    v_lshlrev_b32 v158, 16, v158
    v_cvt_pk_bf16_f32 v159, v95, v95
    v_lshlrev_b32 v159, 16, v159
    v_cvt_pk_bf16_f32 v160, v96, v96
    v_lshlrev_b32 v160, 16, v160
    v_cvt_pk_bf16_f32 v161, v97, v97
    v_lshlrev_b32 v161, 16, v161
    v_cvt_pk_bf16_f32 v162, v98, v98
    v_lshlrev_b32 v162, 16, v162
    v_cvt_pk_bf16_f32 v163, v99, v99
    v_lshlrev_b32 v163, 16, v163
    v_cvt_pk_bf16_f32 v164, v100, v100
    v_lshlrev_b32 v164, 16, v164
    v_cvt_pk_bf16_f32 v165, v101, v101
    v_lshlrev_b32 v165, 16, v165
    v_cvt_pk_bf16_f32 v166, v102, v102
    v_lshlrev_b32 v166, 16, v166
    v_cvt_pk_bf16_f32 v167, v103, v103
    v_lshlrev_b32 v167, 16, v167
    v_cvt_pk_bf16_f32 v168, v104, v104
    v_lshlrev_b32 v168, 16, v168
    v_cvt_pk_bf16_f32 v169, v105, v105
    v_lshlrev_b32 v169, 16, v169
    v_cvt_pk_bf16_f32 v170, v106, v106
    v_lshlrev_b32 v170, 16, v170
    v_cvt_pk_bf16_f32 v171, v107, v107
    v_lshlrev_b32 v171, 16, v171
    v_cvt_pk_bf16_f32 v172, v108, v108
    v_lshlrev_b32 v172, 16, v172
    v_cvt_pk_bf16_f32 v173, v109, v109
    v_lshlrev_b32 v173, 16, v173
    v_cvt_pk_bf16_f32 v174, v110, v110
    v_lshlrev_b32 v174, 16, v174
    v_cvt_pk_bf16_f32 v175, v111, v111
    v_lshlrev_b32 v175, 16, v175
    s_mov_b32 s12, s24
    s_mov_b32 s13, s25
    s_mov_b32 s14, 4194304
    s_mov_b32 s15, 0x00020000
    s_mov_b32 s20, s26
    s_mov_b32 s21, s27
    s_mov_b32 s22, 4194304
    s_mov_b32 s23, 0x00020000
    v_and_b32 v1, 1, v7
    v_lshlrev_b32 v1, 7, v1
    v_lshrrev_b32 v8, 5, v6
    v_lshlrev_b32 v8, 3, v8
    s_lshl_b32 s34, s4, 8
    v_add3_u32 v14, v1, v8, s34
    v_lshrrev_b32 v1, 1, v7
    v_lshlrev_b32 v1, 5, v1
    v_and_b32 v8, 31, v6
    s_lshl_b32 s34, s3, 6
    v_add3_u32 v1, v1, v8, s34
    v_lshlrev_b32 v12, 11, v1
    v_add_u32 v12, v12, v14
    s_mov_b32 s36, 92274688
    buffer_load_dwordx2 v[16:17], v12, s[8:11], s36 offen offset:0 sc1
    buffer_load_dwordx2 v[32:33], v12, s[12:15], 0 offen offset:0
    buffer_load_dwordx2 v[18:19], v12, s[8:11], s36 offen offset:16 sc1
    buffer_load_dwordx2 v[34:35], v12, s[12:15], 0 offen offset:16
    buffer_load_dwordx2 v[20:21], v12, s[8:11], s36 offen offset:32 sc1
    buffer_load_dwordx2 v[36:37], v12, s[12:15], 0 offen offset:32
    buffer_load_dwordx2 v[22:23], v12, s[8:11], s36 offen offset:48 sc1
    buffer_load_dwordx2 v[38:39], v12, s[12:15], 0 offen offset:48
    buffer_load_dwordx2 v[24:25], v12, s[8:11], s36 offen offset:64 sc1
    buffer_load_dwordx2 v[40:41], v12, s[12:15], 0 offen offset:64
    buffer_load_dwordx2 v[26:27], v12, s[8:11], s36 offen offset:80 sc1
    buffer_load_dwordx2 v[42:43], v12, s[12:15], 0 offen offset:80
    buffer_load_dwordx2 v[28:29], v12, s[8:11], s36 offen offset:96 sc1
    buffer_load_dwordx2 v[44:45], v12, s[12:15], 0 offen offset:96
    buffer_load_dwordx2 v[30:31], v12, s[8:11], s36 offen offset:112 sc1
    buffer_load_dwordx2 v[46:47], v12, s[12:15], 0 offen offset:112
    s_waitcnt vmcnt(0)
    v_lshlrev_b32 v48, 16, v16
    v_lshlrev_b32 v49, 16, v32
    v_add_f32 v49, v49, v144
    v_cvt_pk_bf16_f32 v49, v49, v49
    v_lshlrev_b32 v49, 16, v49
    v_add_f32 v80, v48, v49
    v_and_b32 v48, 0xffff0000, v16
    v_and_b32 v49, 0xffff0000, v32
    v_add_f32 v49, v49, v145
    v_cvt_pk_bf16_f32 v49, v49, v49
    v_lshlrev_b32 v49, 16, v49
    v_add_f32 v81, v48, v49
    v_lshlrev_b32 v48, 16, v17
    v_lshlrev_b32 v49, 16, v33
    v_add_f32 v49, v49, v146
    v_cvt_pk_bf16_f32 v49, v49, v49
    v_lshlrev_b32 v49, 16, v49
    v_add_f32 v82, v48, v49
    v_and_b32 v48, 0xffff0000, v17
    v_and_b32 v49, 0xffff0000, v33
    v_add_f32 v49, v49, v147
    v_cvt_pk_bf16_f32 v49, v49, v49
    v_lshlrev_b32 v49, 16, v49
    v_add_f32 v83, v48, v49
    v_cvt_pk_bf16_f32 v50, v80, v81
    v_cvt_pk_bf16_f32 v51, v82, v83
    buffer_store_dwordx2 v[50:51], v12, s[20:23], 0 offen offset:0
    s_nop 1
    v_lshlrev_b32 v48, 16, v18
    v_lshlrev_b32 v49, 16, v34
    v_add_f32 v49, v49, v148
    v_cvt_pk_bf16_f32 v49, v49, v49
    v_lshlrev_b32 v49, 16, v49
    v_add_f32 v84, v48, v49
    v_and_b32 v48, 0xffff0000, v18
    v_and_b32 v49, 0xffff0000, v34
    v_add_f32 v49, v49, v149
    v_cvt_pk_bf16_f32 v49, v49, v49
    v_lshlrev_b32 v49, 16, v49
    v_add_f32 v85, v48, v49
    v_lshlrev_b32 v48, 16, v19
    v_lshlrev_b32 v49, 16, v35
    v_add_f32 v49, v49, v150
    v_cvt_pk_bf16_f32 v49, v49, v49
    v_lshlrev_b32 v49, 16, v49
    v_add_f32 v86, v48, v49
    v_and_b32 v48, 0xffff0000, v19
    v_and_b32 v49, 0xffff0000, v35
    v_add_f32 v49, v49, v151
    v_cvt_pk_bf16_f32 v49, v49, v49
    v_lshlrev_b32 v49, 16, v49
    v_add_f32 v87, v48, v49
    v_cvt_pk_bf16_f32 v50, v84, v85
    v_cvt_pk_bf16_f32 v51, v86, v87
    buffer_store_dwordx2 v[50:51], v12, s[20:23], 0 offen offset:16
    s_nop 1
    v_lshlrev_b32 v48, 16, v20
    v_lshlrev_b32 v49, 16, v36
    v_add_f32 v49, v49, v152
    v_cvt_pk_bf16_f32 v49, v49, v49
    v_lshlrev_b32 v49, 16, v49
    v_add_f32 v88, v48, v49
    v_and_b32 v48, 0xffff0000, v20
    v_and_b32 v49, 0xffff0000, v36
    v_add_f32 v49, v49, v153
    v_cvt_pk_bf16_f32 v49, v49, v49
    v_lshlrev_b32 v49, 16, v49
    v_add_f32 v89, v48, v49
    v_lshlrev_b32 v48, 16, v21
    v_lshlrev_b32 v49, 16, v37
    v_add_f32 v49, v49, v154
    v_cvt_pk_bf16_f32 v49, v49, v49
    v_lshlrev_b32 v49, 16, v49
    v_add_f32 v90, v48, v49
    v_and_b32 v48, 0xffff0000, v21
    v_and_b32 v49, 0xffff0000, v37
    v_add_f32 v49, v49, v155
    v_cvt_pk_bf16_f32 v49, v49, v49
    v_lshlrev_b32 v49, 16, v49
    v_add_f32 v91, v48, v49
    v_cvt_pk_bf16_f32 v50, v88, v89
    v_cvt_pk_bf16_f32 v51, v90, v91
    buffer_store_dwordx2 v[50:51], v12, s[20:23], 0 offen offset:32
    s_nop 1
    v_lshlrev_b32 v48, 16, v22
    v_lshlrev_b32 v49, 16, v38
    v_add_f32 v49, v49, v156
    v_cvt_pk_bf16_f32 v49, v49, v49
    v_lshlrev_b32 v49, 16, v49
    v_add_f32 v92, v48, v49
    v_and_b32 v48, 0xffff0000, v22
    v_and_b32 v49, 0xffff0000, v38
    v_add_f32 v49, v49, v157
    v_cvt_pk_bf16_f32 v49, v49, v49
    v_lshlrev_b32 v49, 16, v49
    v_add_f32 v93, v48, v49
    v_lshlrev_b32 v48, 16, v23
    v_lshlrev_b32 v49, 16, v39
    v_add_f32 v49, v49, v158
    v_cvt_pk_bf16_f32 v49, v49, v49
    v_lshlrev_b32 v49, 16, v49
    v_add_f32 v94, v48, v49
    v_and_b32 v48, 0xffff0000, v23
    v_and_b32 v49, 0xffff0000, v39
    v_add_f32 v49, v49, v159
    v_cvt_pk_bf16_f32 v49, v49, v49
    v_lshlrev_b32 v49, 16, v49
    v_add_f32 v95, v48, v49
    v_cvt_pk_bf16_f32 v50, v92, v93
    v_cvt_pk_bf16_f32 v51, v94, v95
    buffer_store_dwordx2 v[50:51], v12, s[20:23], 0 offen offset:48
    s_nop 1
    v_lshlrev_b32 v48, 16, v24
    v_lshlrev_b32 v49, 16, v40
    v_add_f32 v49, v49, v160
    v_cvt_pk_bf16_f32 v49, v49, v49
    v_lshlrev_b32 v49, 16, v49
    v_add_f32 v96, v48, v49
    v_and_b32 v48, 0xffff0000, v24
    v_and_b32 v49, 0xffff0000, v40
    v_add_f32 v49, v49, v161
    v_cvt_pk_bf16_f32 v49, v49, v49
    v_lshlrev_b32 v49, 16, v49
    v_add_f32 v97, v48, v49
    v_lshlrev_b32 v48, 16, v25
    v_lshlrev_b32 v49, 16, v41
    v_add_f32 v49, v49, v162
    v_cvt_pk_bf16_f32 v49, v49, v49
    v_lshlrev_b32 v49, 16, v49
    v_add_f32 v98, v48, v49
    v_and_b32 v48, 0xffff0000, v25
    v_and_b32 v49, 0xffff0000, v41
    v_add_f32 v49, v49, v163
    v_cvt_pk_bf16_f32 v49, v49, v49
    v_lshlrev_b32 v49, 16, v49
    v_add_f32 v99, v48, v49
    v_cvt_pk_bf16_f32 v50, v96, v97
    v_cvt_pk_bf16_f32 v51, v98, v99
    buffer_store_dwordx2 v[50:51], v12, s[20:23], 0 offen offset:64
    s_nop 1
    v_lshlrev_b32 v48, 16, v26
    v_lshlrev_b32 v49, 16, v42
    v_add_f32 v49, v49, v164
    v_cvt_pk_bf16_f32 v49, v49, v49
    v_lshlrev_b32 v49, 16, v49
    v_add_f32 v100, v48, v49
    v_and_b32 v48, 0xffff0000, v26
    v_and_b32 v49, 0xffff0000, v42
    v_add_f32 v49, v49, v165
    v_cvt_pk_bf16_f32 v49, v49, v49
    v_lshlrev_b32 v49, 16, v49
    v_add_f32 v101, v48, v49
    v_lshlrev_b32 v48, 16, v27
    v_lshlrev_b32 v49, 16, v43
    v_add_f32 v49, v49, v166
    v_cvt_pk_bf16_f32 v49, v49, v49
    v_lshlrev_b32 v49, 16, v49
    v_add_f32 v102, v48, v49
    v_and_b32 v48, 0xffff0000, v27
    v_and_b32 v49, 0xffff0000, v43
    v_add_f32 v49, v49, v167
    v_cvt_pk_bf16_f32 v49, v49, v49
    v_lshlrev_b32 v49, 16, v49
    v_add_f32 v103, v48, v49
    v_cvt_pk_bf16_f32 v50, v100, v101
    v_cvt_pk_bf16_f32 v51, v102, v103
    buffer_store_dwordx2 v[50:51], v12, s[20:23], 0 offen offset:80
    s_nop 1
    v_lshlrev_b32 v48, 16, v28
    v_lshlrev_b32 v49, 16, v44
    v_add_f32 v49, v49, v168
    v_cvt_pk_bf16_f32 v49, v49, v49
    v_lshlrev_b32 v49, 16, v49
    v_add_f32 v104, v48, v49
    v_and_b32 v48, 0xffff0000, v28
    v_and_b32 v49, 0xffff0000, v44
    v_add_f32 v49, v49, v169
    v_cvt_pk_bf16_f32 v49, v49, v49
    v_lshlrev_b32 v49, 16, v49
    v_add_f32 v105, v48, v49
    v_lshlrev_b32 v48, 16, v29
    v_lshlrev_b32 v49, 16, v45
    v_add_f32 v49, v49, v170
    v_cvt_pk_bf16_f32 v49, v49, v49
    v_lshlrev_b32 v49, 16, v49
    v_add_f32 v106, v48, v49
    v_and_b32 v48, 0xffff0000, v29
    v_and_b32 v49, 0xffff0000, v45
    v_add_f32 v49, v49, v171
    v_cvt_pk_bf16_f32 v49, v49, v49
    v_lshlrev_b32 v49, 16, v49
    v_add_f32 v107, v48, v49
    v_cvt_pk_bf16_f32 v50, v104, v105
    v_cvt_pk_bf16_f32 v51, v106, v107
    buffer_store_dwordx2 v[50:51], v12, s[20:23], 0 offen offset:96
    s_nop 1
    v_lshlrev_b32 v48, 16, v30
    v_lshlrev_b32 v49, 16, v46
    v_add_f32 v49, v49, v172
    v_cvt_pk_bf16_f32 v49, v49, v49
    v_lshlrev_b32 v49, 16, v49
    v_add_f32 v108, v48, v49
    v_and_b32 v48, 0xffff0000, v30
    v_and_b32 v49, 0xffff0000, v46
    v_add_f32 v49, v49, v173
    v_cvt_pk_bf16_f32 v49, v49, v49
    v_lshlrev_b32 v49, 16, v49
    v_add_f32 v109, v48, v49
    v_lshlrev_b32 v48, 16, v31
    v_lshlrev_b32 v49, 16, v47
    v_add_f32 v49, v49, v174
    v_cvt_pk_bf16_f32 v49, v49, v49
    v_lshlrev_b32 v49, 16, v49
    v_add_f32 v110, v48, v49
    v_and_b32 v48, 0xffff0000, v31
    v_and_b32 v49, 0xffff0000, v47
    v_add_f32 v49, v49, v175
    v_cvt_pk_bf16_f32 v49, v49, v49
    v_lshlrev_b32 v49, 16, v49
    v_add_f32 v111, v48, v49
    v_cvt_pk_bf16_f32 v50, v108, v109
    v_cvt_pk_bf16_f32 v51, v110, v111
    buffer_store_dwordx2 v[50:51], v12, s[20:23], 0 offen offset:112
    s_nop 1
op_skip:
    s_barrier
wk_p4n:
    s_add_u32 s73, s73, 1
    s_cmp_lt_u32 s73, 3
    s_cbranch_scc1 wk_p4
    s_branch rec_done
rec_done:
    s_endpgm

.section .rodata,"a"
.p2align 6
.amdhsa_kernel ln_kernel
  .amdhsa_next_free_vgpr 48
  .amdhsa_next_free_sgpr 24
  .amdhsa_accum_offset 48
  .amdhsa_group_segment_fixed_size 0
  .amdhsa_kernarg_size 120
  .amdhsa_user_sgpr_count 2
  .amdhsa_user_sgpr_kernarg_segment_ptr 1
  .amdhsa_system_sgpr_workgroup_id_x 1
.end_amdhsa_kernel

.p2align 6
.amdhsa_kernel rec_kernel
  .amdhsa_next_free_vgpr 256
  .amdhsa_next_free_sgpr 96
  .amdhsa_accum_offset 256
  .amdhsa_group_segment_fixed_size 0
  .amdhsa_kernarg_size 120
  .amdhsa_user_sgpr_count 2
  .amdhsa_user_sgpr_kernarg_segment_ptr 1
  .amdhsa_system_sgpr_workgroup_id_x 1
.end_amdhsa_kernel
```
